```python
import torch

def _softmax(x, axis=-1):
    return torch.softmax(x, dim=axis)
def _gelu(x):
    return torch.nn.functional.gelu(x, approximate="tanh")
def _silu(x):
    return torch.nn.functional.silu(x)
def _sigmoid(x):
    return torch.sigmoid(x)
def _layernorm(x, axis=-1, eps=1e-5):
    m = x.mean(dim=axis, keepdim=True)
    v = x.var(dim=axis, keepdim=True, unbiased=False)
    return (x - m) / torch.sqrt(v + eps)
def _scatter_add(tgt, idx, src, axis=0):
    return tgt.clone().index_add_(axis, idx, src)
def _segment_sum(src, seg, n):
    out = torch.zeros((n,) + src.shape[1:], dtype=src.dtype)
    return out.index_add_(0, seg, src)
def _pad(x, pw):
    flat = tuple(v for pair in reversed(pw) for v in pair)
    return torch.nn.functional.pad(x, flat)

kernel_name = 'sequential_preLN__spectral_gfnet__mixer_token_mlp__prompt'

def setup_inputs():

    _w = (lambda a: (lambda t: t.to(torch.bfloat16) if t.is_floating_point() else t)(torch.as_tensor(a)))
    def _A_setup():
        B, S, D = 1, 2048, 1024
        Df = D // 2 + 1
        return {
            "x": _w((lambda *s: torch.randn(*s, dtype=torch.bfloat16) * 0.05)(B, S, D)),
            "w_r": _w((lambda *s: torch.randn(*s, dtype=torch.bfloat16) * 0.4)(S, Df) * 0.02),
            "w_i": _w((lambda *s: torch.randn(*s, dtype=torch.bfloat16) * 0.4)(S, Df) * 0.02),
        }
    _A_in = _A_setup()

    def _B_setup():
        B, S, D, F = 1, 2048, 1024, 3584
        return {
            "x": _w((lambda *s: torch.randn(*s, dtype=torch.bfloat16) * 0.05)(B, S, D)),
            "w1": _w((lambda *s: torch.randn(*s, dtype=torch.bfloat16) * 0.4)(S, F) * (S ** -0.5)),
            "b1": _w((lambda *s: torch.randn(*s, dtype=torch.bfloat16) * 3.2)(F) * 0.02),
            "w2": _w((lambda *s: torch.randn(*s, dtype=torch.bfloat16) * 0.8)(F, S) * (F ** -0.5)),
            "b2": _w((lambda *s: torch.randn(*s, dtype=torch.bfloat16) * 3.2)(S) * 0.02),
        }
    _B_in = _B_setup()

    return {
        "A_x": _A_in["x"],
        "A_w_r": _A_in["w_r"],
        "A_w_i": _A_in["w_i"],
        "B_x": _B_in["x"],
        "B_w1": _B_in["w1"],
        "B_b1": _B_in["b1"],
        "B_w2": _B_in["w2"],
        "B_b2": _B_in["b2"],
    }

def reference(A_x, A_w_r, A_w_i, B_x, B_w1, B_b1, B_w2, B_b2):
    def _A_ref(x, w_r, w_i):
        B, S, D = x.shape
        X = (lambda x, axes=(-2,-1): torch.fft.rfft2(x.float(), dim=axes))(x, axes=(-2, -1))
        W = w_r + 1j * w_i
        X = X * W
        y = (lambda x, s, axes=(-2,-1): torch.fft.irfft2(x, s=s, dim=axes).to(torch.bfloat16))(X, (S, D), axes=(-2, -1))
        return y

    def _B_ref(x, w1, b1, w2, b2):
        B, S, D = x.shape
        h = _layernorm(x, axis=-1)
        u = torch.einsum("bsd,sf->bdf", h, w1) + b1
        u = _gelu(u)
        y = torch.einsum("bdf,fs->bds", u, w2) + b2
        return (lambda x, *d: x.permute(*d))(y, 0, 2, 1)

    x = A_x
    h = x + _A_ref(_layernorm(x, axis=-1), A_w_r, A_w_i)
    h2 = h + _B_ref(_layernorm(h, axis=-1), B_w1, B_b1, B_w2, B_b2)
    return h2
```

```asm
; @launch grid=(256,1,1) block=(512,1,1) lds=152064
.amdgcn_target "amdgcn-amd-amdhsa--gfx950"
.text
.globl sequential_preLN__spectral_gfnet__mixer_token_mlp__prompt_kernel
.p2align 8
.type sequential_preLN__spectral_gfnet__mixer_token_mlp__prompt_kernel,@function
sequential_preLN__spectral_gfnet__mixer_token_mlp__prompt_kernel:
  s_cmp_ge_u32 s2, 256
  s_cbranch_scc1 k_exit
  s_load_dwordx4 s[64:67], s[0:1], 0
  s_load_dwordx2 s[68:69], s[0:1], 16
  s_load_dwordx2 s[70:71], s[0:1], 32
  s_load_dwordx4 s[72:75], s[0:1], 40
  s_load_dwordx4 s[76:79], s[0:1], 56
  s_load_dwordx4 s[80:83], s[0:1], 72
  v_lshrrev_b32 v6, 6, v0
  v_and_b32 v7, 63, v0
  v_readfirstlane_b32 s20, v6
  v_and_b32 v8, 15, v7
  v_lshrrev_b32 v9, 4, v7
  s_waitcnt lgkmcnt(0)
  s_add_u32 s12, s82, 31457280
  s_addc_u32 s13, s83, 0
  s_mov_b32 s14, 65536
  s_mov_b32 s15, 0x00020000
  s_mov_b32 s24, s64
  s_mov_b32 s25, s65
  s_mov_b32 s26, 4194304
  s_mov_b32 s27, 0x00020000
  s_mov_b32 s28, s82
  s_mov_b32 s29, s83
  s_mov_b32 s30, 4194304
  s_mov_b32 s31, 0x00020000
  s_lshl_b32 s46, s20, 8
  s_add_u32 s46, s46, s2
  s_lshl_b32 s47, s46, 11
  v_lshlrev_b32 v1, 9, v9
  v_lshl_add_u32 v1, v8, 2, v1
  s_cmp_ge_u32 s2, 16
  s_cbranch_scc1 p1_noreset
  s_cmp_lg_u32 s20, 0
  s_cbranch_scc1 p1_noreset
  s_lshl_b32 s48, s2, 8
  v_lshlrev_b32 v2, 12, v7
  v_add_u32 v2, s48, v2
  v_mov_b32 v3, 0
  s_mov_b64 s[48:49], exec
  s_mov_b64 exec, 15
  buffer_store_dword v3, v2, s[12:15], 0 offen sc1
  s_mov_b64 exec, s[48:49]
p1_noreset:
  buffer_load_dword v32, v1, s[24:27], s47 offen offset:0
  buffer_load_dword v33, v1, s[24:27], s47 offen offset:64
  buffer_load_dword v34, v1, s[24:27], s47 offen offset:128
  buffer_load_dword v35, v1, s[24:27], s47 offen offset:192
  buffer_load_dword v36, v1, s[24:27], s47 offen offset:256
  buffer_load_dword v37, v1, s[24:27], s47 offen offset:320
  buffer_load_dword v38, v1, s[24:27], s47 offen offset:384
  buffer_load_dword v39, v1, s[24:27], s47 offen offset:448
  v_lshlrev_b32 v5, 15, v9
  v_lshl_add_u32 v5, v8, 2, v5
  s_and_b32 s52, s2, 15
  s_lshl_b32 s52, s52, 4
  s_lshr_b32 s53, s2, 4
  s_add_u32 s52, s52, s53
  s_lshl_b32 s52, s52, 6
  s_lshl_b32 s53, s20, 19
  s_add_u32 s44, s52, s53
  s_cmp_lg_u32 s20, 7
  s_cbranch_scc1 p1_notlb
  v_lshlrev_b32 v2, 21, v7
  s_mov_b32 s56, s82
  s_mov_b32 s57, s83
  s_mov_b32 s58, 37748736
  s_mov_b32 s59, 0x00020000
  s_mov_b64 s[16:17], exec
  s_mov_b64 exec, 0x3ffff
  buffer_load_dword v230, v2, s[56:59], 0 offen sc1
  s_mov_b64 exec, s[16:17]
  s_mov_b32 s56, s70
  s_mov_b32 s57, s71
  s_mov_b32 s58, 14680064
  s_mov_b32 s59, 0x00020000
  s_mov_b64 s[16:17], exec
  s_mov_b64 exec, 0x7f
  buffer_load_dword v230, v2, s[56:59], 0 offen sc1
  s_mov_b64 exec, s[16:17]
  s_mov_b32 s56, s74
  s_mov_b32 s57, s75
  s_mov_b32 s58, 14680064
  s_mov_b32 s59, 0x00020000
  s_mov_b64 s[16:17], exec
  s_mov_b64 exec, 0x7f
  buffer_load_dword v230, v2, s[56:59], 0 offen sc1
  s_mov_b64 exec, s[16:17]
  s_mov_b32 s56, s66
  s_mov_b32 s57, s67
  s_mov_b32 s58, 2101248
  s_mov_b32 s59, 0x00020000
  s_mov_b64 s[16:17], exec
  s_mov_b64 exec, 0x3
  buffer_load_dword v230, v2, s[56:59], 0 offen sc1
  s_mov_b64 exec, s[16:17]
  s_mov_b32 s56, s68
  s_mov_b32 s57, s69
  s_mov_b32 s58, 2101248
  s_mov_b32 s59, 0x00020000
  s_mov_b64 s[16:17], exec
  s_mov_b64 exec, 0x3
  buffer_load_dword v230, v2, s[56:59], 0 offen sc1
  s_mov_b64 exec, s[16:17]
  s_mov_b32 s56, s78
  s_mov_b32 s57, s79
  s_mov_b32 s58, 4194304
  s_mov_b32 s59, 0x00020000
  s_mov_b64 s[16:17], exec
  s_mov_b64 exec, 0x3
  buffer_load_dword v230, v2, s[56:59], 0 offen sc1
  s_mov_b64 exec, s[16:17]
  s_mov_b32 s56, s72
  s_mov_b32 s57, s73
  s_mov_b32 s58, 7168
  s_mov_b32 s59, 0x00020000
  s_mov_b64 s[16:17], exec
  s_mov_b64 exec, 0x1
  buffer_load_dword v230, v2, s[56:59], 0 offen sc1
  s_mov_b64 exec, s[16:17]
  s_mov_b32 s56, s76
  s_mov_b32 s57, s77
  s_mov_b32 s58, 4096
  s_mov_b32 s59, 0x00020000
  s_mov_b64 s[16:17], exec
  s_mov_b64 exec, 0x1
  buffer_load_dword v230, v2, s[56:59], 0 offen sc1
  s_mov_b64 exec, s[16:17]
p1_notlb:
  v_and_b32 v10, 255, v0
  v_lshrrev_b32 v11, 8, v0
  v_bfe_u32 v12, v10, 2, 4
  v_lshl_add_u32 v12, v11, 4, v12
  v_lshrrev_b32 v13, 6, v10
  v_and_b32 v14, 3, v10
  v_lshlrev_b32 v13, 3, v13
  v_lshl_add_u32 v13, v14, 1, v13
  v_mul_u32_u24 v15, v13, v12
  v_add_u32 v16, v15, v12
  v_and_b32 v21, 31, v15
  v_cvt_f32_u32 v21, v21
  v_mul_f32 v21, 0x3d000000, v21
  v_cos_f32 v17, v21
  v_sin_f32 v18, v21
  v_and_b32 v21, 31, v16
  v_cvt_f32_u32 v21, v21
  v_mul_f32 v21, 0x3d000000, v21
  v_cos_f32 v19, v21
  v_sin_f32 v20, v21
  v_lshlrev_b32 v22, 2, v10
  v_lshl_add_u32 v22, v11, 11, v22
  v_cvt_pk_bf16_f32 v23, v17, v19
  v_cvt_pk_bf16_f32 v24, -v18, -v20
  ds_write_b32 v22, v23 offset:0
  ds_write_b32 v22, v24 offset:1024
  v_and_b32 v21, 1023, v15
  v_cvt_f32_u32 v21, v21
  v_mul_f32 v21, 0x3a800000, v21
  v_cos_f32 v17, v21
  v_sin_f32 v18, v21
  v_and_b32 v21, 1023, v16
  v_cvt_f32_u32 v21, v21
  v_mul_f32 v21, 0x3a800000, v21
  v_cos_f32 v19, v21
  v_sin_f32 v20, v21
  ds_write_b32 v22, v17 offset:8192
  ds_write_b32 v22, v18 offset:9216
  ds_write_b32 v22, v19 offset:12288
  ds_write_b32 v22, v20 offset:13312
  v_bfe_u32 v12, v10, 2, 4
  v_mul_u32_u24 v15, v13, v12
  v_add_u32 v16, v15, v12
  v_and_b32 v21, 31, v15
  v_cvt_f32_u32 v21, v21
  v_mul_f32 v21, 0x3d000000, v21
  v_cos_f32 v17, v21
  v_sin_f32 v18, v21
  v_and_b32 v21, 31, v16
  v_cvt_f32_u32 v21, v21
  v_mul_f32 v21, 0x3d000000, v21
  v_cos_f32 v19, v21
  v_sin_f32 v20, v21
  v_lshlrev_b32 v22, 2, v10
  v_cvt_pk_bf16_f32 v23, v17, v19
  v_cvt_pk_bf16_f32 v24, v18, v20
  v_cvt_pk_bf16_f32 v25, -v18, -v20
  ds_write_b32 v22, v23 offset:4096
  ds_write_b32 v22, v24 offset:5120
  ds_write_b32 v22, v25 offset:6144
  v_lshrrev_b32 v10, 1, v8
  v_lshlrev_b32 v11, 9, v9
  v_add_u32 v11, s2, v11
  v_add_u32 v12, 256, v11
  v_mul_u32_u24 v11, v10, v11
  v_mul_u32_u24 v12, v10, v12
  v_and_b32 v17, 2047, v11
  v_cvt_f32_u32 v17, v17
  v_mul_f32 v17, 0x3a000000, v17
  v_cos_f32 v13, v17
  v_sin_f32 v14, v17
  v_and_b32 v17, 2047, v12
  v_cvt_f32_u32 v17, v17
  v_mul_f32 v17, 0x3a000000, v17
  v_cos_f32 v15, v17
  v_sin_f32 v16, v17
  v_and_b32 v17, 1, v8
  v_cmp_eq_u32 vcc, 1, v17
  s_nop 1
  v_cndmask_b32 v18, v13, v14, vcc
  v_cndmask_b32 v19, v14, v13, vcc
  v_xor_b32 v17, 0x80000000, v18
  v_cndmask_b32 v18, v18, v17, vcc
  v_cvt_pk_bf16_f32 v30, v18, v19
  v_cndmask_b32 v18, v15, v16, vcc
  v_cndmask_b32 v19, v16, v15, vcc
  v_xor_b32 v17, 0x80000000, v18
  v_cndmask_b32 v18, v18, v17, vcc
  v_cvt_pk_bf16_f32 v31, v18, v19
  s_mov_b32 s56, s80
  s_mov_b32 s57, s81
  s_mov_b32 s58, 256
  s_mov_b32 s59, 0x00020000
  s_and_b32 s54, s2, 15
  s_lshl_b32 s55, s54, 2
  s_add_u32 s55, s55, 64
  v_mov_b32 v25, s55
  v_lshlrev_b32 v26, 2, v8
  v_add_u32 v26, 64, v26
  s_cmp_ge_u32 s2, 16
  s_cbranch_scc1 p1_noflag
  s_cmp_lg_u32 s20, 0
  s_cbranch_scc1 p1_noflag
  s_waitcnt vmcnt(8)
  v_mov_b32 v3, 1
  s_mov_b64 s[48:49], exec
  s_mov_b64 exec, 1
  buffer_store_dword v3, v25, s[56:59], 0 offen sc1
  s_mov_b64 exec, s[48:49]
p1_noflag:
  s_waitcnt lgkmcnt(0)
  s_barrier
  s_mul_i32 s54, s2, 8208
  s_mul_i32 s54, s2, 57344
  s_cmp_lt_u32 s20, 4
  s_cbranch_scc1 pf_p1c
  s_mov_b32 s56, s70
  s_mov_b32 s57, s71
  s_mov_b32 s58, 14680064
  s_mov_b32 s59, 0x00020000
  s_sub_u32 s55, s20, 4
  s_mul_i32 s55, s55, 4096
  s_add_u32 s55, s55, s54
  v_lshlrev_b32 v29, 4, v7
  buffer_load_dwordx4 v[232:235], v29, s[56:59], s55 offen offset:0
  buffer_load_dwordx4 v[232:235], v29, s[56:59], s55 offen offset:1024
  buffer_load_dwordx4 v[232:235], v29, s[56:59], s55 offen offset:2048
  buffer_load_dwordx4 v[232:235], v29, s[56:59], s55 offen offset:3072
pf_p1c:
  v_lshlrev_b32 v2, 4, v7
  ds_read_b128 v[96:99], v2 offset:0
  ds_read_b128 v[100:103], v2 offset:1024
  ds_read_b128 v[104:107], v2 offset:2048
  ds_read_b128 v[108:111], v2 offset:3072
  ds_read_b128 v[112:115], v2 offset:4096
  ds_read_b128 v[116:119], v2 offset:5120
  ds_read_b128 v[120:123], v2 offset:6144
  ds_read_b128 v[128:131], v2 offset:8192
  ds_read_b128 v[132:135], v2 offset:9216
  ds_read_b128 v[136:139], v2 offset:10240
  ds_read_b128 v[140:143], v2 offset:11264
  ds_read_b128 v[144:147], v2 offset:12288
  ds_read_b128 v[148:151], v2 offset:13312
  ds_read_b128 v[152:155], v2 offset:14336
  ds_read_b128 v[156:159], v2 offset:15360
  s_cmp_eq_u32 s20, 3
  s_cbranch_scc1 p1_xw0
  s_cmp_ge_u32 s20, 4
  s_cbranch_scc1 p1_xw4
  s_waitcnt vmcnt(0)
  s_branch p1_xwd
p1_xw4:
  s_cmp_lg_u32 s20, 7
  s_cbranch_scc1 p1_xw5
  s_waitcnt vmcnt(12)
  s_branch p1_xwd
p1_xw5:
  s_waitcnt vmcnt(4)
  s_branch p1_xwd
p1_xw0:
  s_waitcnt vmcnt(0)
p1_xwd:
  s_mov_b32 s56, s80
  s_mov_b32 s57, s81
  s_mov_b32 s58, 256
  s_mov_b32 s59, 0x00020000
  v_lshlrev_b32 v40, 16, v32
  v_and_b32 v48, 0xffff0000, v32
  v_lshlrev_b32 v41, 16, v33
  v_and_b32 v49, 0xffff0000, v33
  v_lshlrev_b32 v42, 16, v34
  v_and_b32 v50, 0xffff0000, v34
  v_lshlrev_b32 v43, 16, v35
  v_and_b32 v51, 0xffff0000, v35
  v_lshlrev_b32 v44, 16, v36
  v_and_b32 v52, 0xffff0000, v36
  v_lshlrev_b32 v45, 16, v37
  v_and_b32 v53, 0xffff0000, v37
  v_lshlrev_b32 v46, 16, v38
  v_and_b32 v54, 0xffff0000, v38
  v_lshlrev_b32 v47, 16, v39
  v_and_b32 v55, 0xffff0000, v39
  v_readlane_b32 s48, v40, 0
  s_nop 1
  v_pk_add_f32 v[40:41], v[40:41], s[48:49] op_sel_hi:[1,0] neg_lo:[0,1] neg_hi:[0,1]
  v_pk_add_f32 v[42:43], v[42:43], s[48:49] op_sel_hi:[1,0] neg_lo:[0,1] neg_hi:[0,1]
  v_pk_add_f32 v[44:45], v[44:45], s[48:49] op_sel_hi:[1,0] neg_lo:[0,1] neg_hi:[0,1]
  v_pk_add_f32 v[46:47], v[46:47], s[48:49] op_sel_hi:[1,0] neg_lo:[0,1] neg_hi:[0,1]
  v_pk_add_f32 v[48:49], v[48:49], s[48:49] op_sel_hi:[1,0] neg_lo:[0,1] neg_hi:[0,1]
  v_pk_add_f32 v[50:51], v[50:51], s[48:49] op_sel_hi:[1,0] neg_lo:[0,1] neg_hi:[0,1]
  v_pk_add_f32 v[52:53], v[52:53], s[48:49] op_sel_hi:[1,0] neg_lo:[0,1] neg_hi:[0,1]
  v_pk_add_f32 v[54:55], v[54:55], s[48:49] op_sel_hi:[1,0] neg_lo:[0,1] neg_hi:[0,1]
  v_pk_add_f32 v[56:57], v[40:41], v[42:43]
  v_pk_add_f32 v[58:59], v[48:49], v[50:51]
  v_pk_mul_f32 v[60:61], v[40:41], v[40:41]
  v_pk_add_f32 v[56:57], v[56:57], v[44:45]
  v_pk_add_f32 v[58:59], v[58:59], v[52:53]
  v_pk_fma_f32 v[60:61], v[42:43], v[42:43], v[60:61]
  v_pk_add_f32 v[56:57], v[56:57], v[46:47]
  v_pk_add_f32 v[58:59], v[58:59], v[54:55]
  v_pk_fma_f32 v[60:61], v[44:45], v[44:45], v[60:61]
  v_pk_fma_f32 v[60:61], v[46:47], v[46:47], v[60:61]
  v_pk_fma_f32 v[60:61], v[48:49], v[48:49], v[60:61]
  v_pk_fma_f32 v[60:61], v[50:51], v[50:51], v[60:61]
  v_pk_fma_f32 v[60:61], v[52:53], v[52:53], v[60:61]
  v_pk_fma_f32 v[60:61], v[54:55], v[54:55], v[60:61]
  v_add_f32 v56, v56, v57
  v_add_f32 v58, v58, v59
  v_add_f32 v60, v60, v61
  v_add_f32_dpp v56, v56, v56 row_ror:8 row_mask:0xf bank_mask:0xf
  v_add_f32_dpp v58, v58, v58 row_ror:8 row_mask:0xf bank_mask:0xf
  v_add_f32_dpp v60, v60, v60 row_ror:8 row_mask:0xf bank_mask:0xf
  v_add_f32_dpp v56, v56, v56 row_ror:4 row_mask:0xf bank_mask:0xf
  v_add_f32_dpp v58, v58, v58 row_ror:4 row_mask:0xf bank_mask:0xf
  v_add_f32_dpp v60, v60, v60 row_ror:4 row_mask:0xf bank_mask:0xf
  v_add_f32_dpp v56, v56, v56 row_ror:2 row_mask:0xf bank_mask:0xf
  v_add_f32_dpp v58, v58, v58 row_ror:2 row_mask:0xf bank_mask:0xf
  v_add_f32_dpp v60, v60, v60 row_ror:2 row_mask:0xf bank_mask:0xf
  v_add_f32_dpp v56, v56, v56 row_ror:1 row_mask:0xf bank_mask:0xf
  v_add_f32_dpp v58, v58, v58 row_ror:1 row_mask:0xf bank_mask:0xf
  v_add_f32_dpp v60, v60, v60 row_ror:1 row_mask:0xf bank_mask:0xf
  v_add_f32_dpp v56, v56, v56 row_bcast:15 row_mask:0xa bank_mask:0xf
  v_add_f32_dpp v58, v58, v58 row_bcast:15 row_mask:0xa bank_mask:0xf
  v_add_f32_dpp v60, v60, v60 row_bcast:15 row_mask:0xa bank_mask:0xf
  v_add_f32_dpp v56, v56, v56 row_bcast:31 row_mask:0xc bank_mask:0xf
  v_add_f32_dpp v58, v58, v58 row_bcast:31 row_mask:0xc bank_mask:0xf
  v_add_f32_dpp v60, v60, v60 row_bcast:31 row_mask:0xc bank_mask:0xf
  v_sub_f32 v57, v56, v58
  v_add_f32 v56, v56, v58
  s_nop 0
  v_readlane_b32 s50, v56, 63
  v_readlane_b32 s51, v60, 63
  v_readlane_b32 s52, v57, 63
  s_nop 0
  v_mov_b32 v56, 0x3a800000
  v_mul_f32 v57, s50, v56
  v_mul_f32 v58, s51, v56
  v_fma_f32 v58, -v57, v57, v58
  v_max_f32 v58, 0, v58
  v_add_f32 v58, 0x3727c5ac, v58
  v_rsq_f32 v60, v58
  s_nop 0
  v_mul_f32 v64, -v57, v60
  v_mul_f32 v62, s52, v60
  v_pk_fma_f32 v[40:41], v[40:41], v[60:61], v[64:65] op_sel_hi:[1,0,0]
  v_pk_fma_f32 v[42:43], v[42:43], v[60:61], v[64:65] op_sel_hi:[1,0,0]
  v_pk_fma_f32 v[44:45], v[44:45], v[60:61], v[64:65] op_sel_hi:[1,0,0]
  v_pk_fma_f32 v[46:47], v[46:47], v[60:61], v[64:65] op_sel_hi:[1,0,0]
  v_pk_fma_f32 v[48:49], v[48:49], v[60:61], v[64:65] op_sel_hi:[1,0,0]
  v_pk_fma_f32 v[50:51], v[50:51], v[60:61], v[64:65] op_sel_hi:[1,0,0]
  v_pk_fma_f32 v[52:53], v[52:53], v[60:61], v[64:65] op_sel_hi:[1,0,0]
  v_pk_fma_f32 v[54:55], v[54:55], v[60:61], v[64:65] op_sel_hi:[1,0,0]
  v_cvt_pk_bf16_f32 v64, v40, v41
  v_cvt_pk_bf16_f32 v65, v42, v43
  v_cvt_pk_bf16_f32 v66, v44, v45
  v_cvt_pk_bf16_f32 v67, v46, v47
  v_cvt_pk_bf16_f32 v68, v48, v49
  v_cvt_pk_bf16_f32 v69, v50, v51
  v_cvt_pk_bf16_f32 v70, v52, v53
  v_cvt_pk_bf16_f32 v71, v54, v55
  s_waitcnt lgkmcnt(0)
  v_readlane_b32 s51, v62, 0
  v_mfma_f32_16x16x32_bf16 v[160:163], v[64:67], v[96:99], 0
  v_mfma_f32_16x16x32_bf16 v[164:167], v[64:67], v[100:103], 0
  v_mfma_f32_16x16x32_bf16 v[168:171], v[64:67], v[104:107], 0
  v_mfma_f32_16x16x32_bf16 v[172:175], v[64:67], v[108:111], 0
  v_mfma_f32_16x16x32_bf16 v[176:179], v[68:71], v[96:99], 0
  v_mfma_f32_16x16x32_bf16 v[180:183], v[68:71], v[100:103], 0
  v_mfma_f32_16x16x32_bf16 v[184:187], v[68:71], v[104:107], 0
  v_mfma_f32_16x16x32_bf16 v[188:191], v[68:71], v[108:111], 0
  s_nop 4
  v_pk_mul_f32 v[32:33], v[164:165], v[132:133]
  v_pk_mul_f32 v[36:37], v[160:161], v[132:133]
  v_pk_mul_f32 v[34:35], v[166:167], v[134:135]
  v_pk_mul_f32 v[38:39], v[162:163], v[134:135]
  v_pk_fma_f32 v[40:41], v[160:161], v[128:129], v[32:33]
  v_pk_fma_f32 v[44:45], v[164:165], v[128:129], v[36:37] neg_lo:[0,0,1] neg_hi:[0,0,1]
  v_pk_fma_f32 v[42:43], v[162:163], v[130:131], v[34:35]
  v_pk_fma_f32 v[46:47], v[166:167], v[130:131], v[38:39] neg_lo:[0,0,1] neg_hi:[0,0,1]
  v_pk_mul_f32 v[32:33], v[180:181], v[148:149]
  v_pk_mul_f32 v[36:37], v[176:177], v[148:149]
  v_pk_mul_f32 v[34:35], v[182:183], v[150:151]
  v_pk_mul_f32 v[38:39], v[178:179], v[150:151]
  v_pk_fma_f32 v[48:49], v[176:177], v[144:145], v[32:33]
  v_pk_fma_f32 v[52:53], v[180:181], v[144:145], v[36:37] neg_lo:[0,0,1] neg_hi:[0,0,1]
  v_pk_fma_f32 v[50:51], v[178:179], v[146:147], v[34:35]
  v_pk_fma_f32 v[54:55], v[182:183], v[146:147], v[38:39] neg_lo:[0,0,1] neg_hi:[0,0,1]
  v_cvt_pk_bf16_f32 v72, v40, v48
  v_cvt_pk_bf16_f32 v76, v44, v52
  v_cvt_pk_bf16_f32 v73, v41, v49
  v_cvt_pk_bf16_f32 v77, v45, v53
  v_cvt_pk_bf16_f32 v74, v42, v50
  v_cvt_pk_bf16_f32 v78, v46, v54
  v_cvt_pk_bf16_f32 v75, v43, v51
  v_cvt_pk_bf16_f32 v79, v47, v55
  v_pk_mul_f32 v[32:33], v[172:173], v[140:141]
  v_pk_mul_f32 v[36:37], v[168:169], v[140:141]
  v_pk_mul_f32 v[34:35], v[174:175], v[142:143]
  v_pk_mul_f32 v[38:39], v[170:171], v[142:143]
  v_pk_fma_f32 v[40:41], v[168:169], v[136:137], v[32:33]
  v_pk_fma_f32 v[44:45], v[172:173], v[136:137], v[36:37] neg_lo:[0,0,1] neg_hi:[0,0,1]
  v_pk_fma_f32 v[42:43], v[170:171], v[138:139], v[34:35]
  v_pk_fma_f32 v[46:47], v[174:175], v[138:139], v[38:39] neg_lo:[0,0,1] neg_hi:[0,0,1]
  v_pk_mul_f32 v[32:33], v[188:189], v[156:157]
  v_pk_mul_f32 v[36:37], v[184:185], v[156:157]
  v_pk_mul_f32 v[34:35], v[190:191], v[158:159]
  v_pk_mul_f32 v[38:39], v[186:187], v[158:159]
  v_pk_fma_f32 v[48:49], v[184:185], v[152:153], v[32:33]
  v_pk_fma_f32 v[52:53], v[188:189], v[152:153], v[36:37] neg_lo:[0,0,1] neg_hi:[0,0,1]
  v_pk_fma_f32 v[50:51], v[186:187], v[154:155], v[34:35]
  v_pk_fma_f32 v[54:55], v[190:191], v[154:155], v[38:39] neg_lo:[0,0,1] neg_hi:[0,0,1]
  v_cvt_pk_bf16_f32 v80, v40, v48
  v_cvt_pk_bf16_f32 v84, v44, v52
  v_cvt_pk_bf16_f32 v81, v41, v49
  v_cvt_pk_bf16_f32 v85, v45, v53
  v_cvt_pk_bf16_f32 v82, v42, v50
  v_cvt_pk_bf16_f32 v86, v46, v54
  v_cvt_pk_bf16_f32 v83, v43, v51
  v_cvt_pk_bf16_f32 v87, v47, v55
  s_nop 1
  v_mfma_f32_16x16x32_bf16 v[160:163], v[112:115], v[72:75], 0
  v_mfma_f32_16x16x32_bf16 v[164:167], v[112:115], v[76:79], 0
  v_mfma_f32_16x16x32_bf16 v[160:163], v[116:119], v[76:79], v[160:163]
  v_mfma_f32_16x16x32_bf16 v[164:167], v[120:123], v[72:75], v[164:167]
  v_mfma_f32_16x16x32_bf16 v[168:171], v[112:115], v[80:83], 0
  v_mfma_f32_16x16x32_bf16 v[172:175], v[112:115], v[84:87], 0
  v_mfma_f32_16x16x32_bf16 v[168:171], v[116:119], v[84:87], v[168:171]
  v_mfma_f32_16x16x32_bf16 v[172:175], v[120:123], v[80:83], v[172:175]
  s_and_b32 s52, s20, 1
  s_lshl_b32 s52, s52, 8
  s_lshr_b32 s53, s20, 1
  s_lshl_b32 s53, s53, 6
  s_add_u32 s52, s52, s53
  v_lshlrev_b32 v3, 12, v9
  v_lshl_add_u32 v3, v8, 2, v3
  v_add_u32 v3, s52, v3
  s_nop 2
  v_writelane_b32 v160, s51, 0
  v_writelane_b32 v164, 0, 0
  v_cvt_pk_bf16_f32 v32, v160, v164
  v_cvt_pk_bf16_f32 v33, v161, v165
  v_cvt_pk_bf16_f32 v34, v162, v166
  v_cvt_pk_bf16_f32 v35, v163, v167
  v_cvt_pk_bf16_f32 v36, v168, v172
  v_cvt_pk_bf16_f32 v37, v169, v173
  v_cvt_pk_bf16_f32 v38, v170, v174
  v_cvt_pk_bf16_f32 v39, v171, v175
  ds_write_b32 v3, v32 offset:16384
  ds_write_b32 v3, v33 offset:17408
  ds_write_b32 v3, v34 offset:18432
  ds_write_b32 v3, v35 offset:19456
  ds_write_b32 v3, v36 offset:16896
  ds_write_b32 v3, v37 offset:17920
  ds_write_b32 v3, v38 offset:18944
  ds_write_b32 v3, v39 offset:19968
  buffer_load_dword v27, v26, s[56:59], 0 offen sc1
  s_waitcnt lgkmcnt(0)
  s_barrier
  v_lshlrev_b32 v4, 6, v9
  v_lshl_add_u32 v4, v8, 2, v4
  s_lshl_b32 s52, s20, 11
  s_add_u32 s52, s52, 16384
  v_add_u32 v4, s52, v4
  ds_read2st64_b32 v[40:41], v4 offset0:0 offset1:1
  ds_read2st64_b32 v[42:43], v4 offset0:2 offset1:3
  ds_read2st64_b32 v[44:45], v4 offset0:4 offset1:5
  ds_read2st64_b32 v[46:47], v4 offset0:6 offset1:7
  s_waitcnt lgkmcnt(3)
  v_mfma_f32_16x16x16_bf16 v[48:51], v[30:31], v[40:41], 0
  s_waitcnt lgkmcnt(2)
  v_mfma_f32_16x16x16_bf16 v[52:55], v[30:31], v[42:43], 0
  s_waitcnt lgkmcnt(1)
  v_mfma_f32_16x16x16_bf16 v[56:59], v[30:31], v[44:45], 0
  s_waitcnt lgkmcnt(0)
  v_mfma_f32_16x16x16_bf16 v[60:63], v[30:31], v[46:47], 0
  s_nop 4
  v_cvt_pk_bf16_f32 v64, v48, v49
  v_cvt_pk_bf16_f32 v65, v50, v51
  s_add_u32 s53, s44, 0
  buffer_store_dword v64, v5, s[28:31], s53 offen sc1
  s_add_u32 s53, s44, 16384
  buffer_store_dword v65, v5, s[28:31], s53 offen sc1
  v_cvt_pk_bf16_f32 v66, v52, v53
  v_cvt_pk_bf16_f32 v67, v54, v55
  s_add_u32 s53, s44, 131072
  buffer_store_dword v66, v5, s[28:31], s53 offen sc1
  s_add_u32 s53, s44, 147456
  buffer_store_dword v67, v5, s[28:31], s53 offen sc1
  v_cvt_pk_bf16_f32 v68, v56, v57
  v_cvt_pk_bf16_f32 v69, v58, v59
  s_add_u32 s53, s44, 262144
  buffer_store_dword v68, v5, s[28:31], s53 offen sc1
  s_add_u32 s53, s44, 278528
  buffer_store_dword v69, v5, s[28:31], s53 offen sc1
  v_cvt_pk_bf16_f32 v70, v60, v61
  v_cvt_pk_bf16_f32 v71, v62, v63
  s_add_u32 s53, s44, 393216
  buffer_store_dword v70, v5, s[28:31], s53 offen sc1
  s_add_u32 s53, s44, 409600
  buffer_store_dword v71, v5, s[28:31], s53 offen sc1
  s_and_b32 s54, s2, 15
  s_waitcnt vmcnt(0)
  s_barrier
  s_cmp_lg_u32 s20, 0
  s_cbranch_scc1 x1_arr_skip
  s_mov_b32 s11, 100000
x1_rdy:
  v_cmp_ne_u32 vcc, 0, v27
  s_nop 1
  s_cmp_eq_u64 vcc, exec
  s_cbranch_scc1 x1_rdy_ok
  buffer_load_dword v27, v26, s[56:59], 0 offen sc1
  s_waitcnt vmcnt(0)
  s_sub_u32 s11, s11, 1
  s_cmp_lg_u32 s11, 0
  s_cbranch_scc1 x1_rdy
x1_rdy_ok:
  s_lshl_b32 s10, s54, 8
  s_add_u32 s10, s10, 0
  v_mov_b32 v228, s10
  v_mov_b32 v229, 1
  s_mov_b64 s[16:17], exec
  s_mov_b64 exec, 1
  buffer_atomic_add v229, v228, s[12:15], 0 offen sc1
  s_mov_b64 exec, s[16:17]
x1_arr_skip:
  s_mov_b32 s24, s82
  s_mov_b32 s25, s83
  s_mov_b32 s26, 4194304
  s_mov_b32 s27, 0x00020000
  s_add_u32 s28, s82, 4194304
  s_addc_u32 s29, s83, 0
  s_mov_b32 s30, 4194304
  s_mov_b32 s31, 0x00020000
  s_mov_b32 s32, s66
  s_mov_b32 s33, s67
  s_mov_b32 s34, 2101248
  s_mov_b32 s35, 0x00020000
  s_mov_b32 s36, s68
  s_mov_b32 s37, s69
  s_mov_b32 s38, 2101248
  s_mov_b32 s39, 0x00020000
  s_and_b32 s46, s2, 7
  s_lshr_b32 s47, s2, 3
  v_and_b32 v10, 1, v0
  v_bfe_u32 v11, v0, 5, 4
  v_bfe_u32 v12, v0, 1, 4
  v_lshl_add_u32 v13, v12, 4, v11
  v_lshlrev_b32 v13, 3, v13
  v_add_u32 v13, s46, v13
  v_mul_u32_u24 v13, 1026, v13
  v_lshlrev_b32 v14, 4, v10
  v_add_u32 v14, v13, v14
  s_lshl_b32 s49, s47, 5
  v_mov_b32 v24, v14
  v_mov_b32 v25, v13
  v_mov_b32 v26, v10
  s_mov_b32 s45, s49
  buffer_load_dwordx4 v[40:43], v24, s[32:35], s45 offen
  buffer_load_dwordx4 v[44:47], v24, s[36:39], s45 offen
  s_cmp_lg_u32 s47, 0
  s_cbranch_scc1 p2_nonyq
  buffer_load_ushort v48, v25, s[32:35], 0 offen offset:1024
  buffer_load_ushort v49, v25, s[36:39], 0 offen offset:1024
  s_waitcnt vmcnt(0)
  v_cmp_eq_u32 vcc, 0, v26
  v_and_b32 v50, 0xffff0000, v40
  v_or_b32 v50, v50, v48
  v_cndmask_b32 v40, v40, v50, vcc
  v_and_b32 v50, 0xffff0000, v44
  v_or_b32 v50, v50, v49
  v_cndmask_b32 v44, v44, v50, vcc
p2_nonyq:
  v_and_b32 v15, 255, v0
  v_bfe_u32 v16, v15, 2, 4
  v_lshrrev_b32 v17, 6, v15
  v_and_b32 v18, 3, v15
  v_lshl_add_u32 v17, v17, 2, v18
  v_mul_u32_u24 v17, v17, v16
  v_and_b32 v20, 15, v17
  v_cvt_f32_u32 v20, v20
  v_mul_f32 v20, 0x3d800000, v20
  v_cos_f32 v18, v20
  v_sin_f32 v19, v20
  v_cmp_gt_u32 vcc, 256, v0
  v_xor_b32 v20, 0x80000000, v19
  s_nop 0
  v_cndmask_b32 v21, v20, v18, vcc
  v_cndmask_b32 v22, v18, v19, vcc
  v_cvt_pk_bf16_f32 v21, v21, v22
  v_lshlrev_b32 v22, 2, v0
  ds_write_b32 v22, v21 offset:32768
  v_lshlrev_b32 v16, 2, v9
  v_add_u32 v17, 0, v16
  v_mul_u32_u24 v17, v17, v8
  v_and_b32 v20, 255, v17
  v_cvt_f32_u32 v20, v20
  v_mul_f32 v20, 0x3b800000, v20
  v_cos_f32 v64, v20
  v_sin_f32 v68, v20
  v_add_u32 v17, 1, v16
  v_mul_u32_u24 v17, v17, v8
  v_and_b32 v20, 255, v17
  v_cvt_f32_u32 v20, v20
  v_mul_f32 v20, 0x3b800000, v20
  v_cos_f32 v65, v20
  v_sin_f32 v69, v20
  v_add_u32 v17, 2, v16
  v_mul_u32_u24 v17, v17, v8
  v_and_b32 v20, 255, v17
  v_cvt_f32_u32 v20, v20
  v_mul_f32 v20, 0x3b800000, v20
  v_cos_f32 v66, v20
  v_sin_f32 v70, v20
  v_add_u32 v17, 3, v16
  v_mul_u32_u24 v17, v17, v8
  v_and_b32 v20, 255, v17
  v_cvt_f32_u32 v20, v20
  v_mul_f32 v20, 0x3b800000, v20
  v_cos_f32 v67, v20
  v_sin_f32 v71, v20
  v_and_b32 v16, 3, v0
  v_mul_u32_u24 v16, 4160, v16
  v_lshrrev_b32 v17, 6, v0
  v_lshl_add_u32 v16, v17, 6, v16
  v_bfe_u32 v17, v0, 2, 2
  v_lshl_add_u32 v16, v17, 2, v16
  v_bfe_u32 v17, v0, 4, 2
  v_lshl_add_u32 v21, v17, 4, v16
  v_xor_b32 v17, 2, v17
  v_lshl_add_u32 v22, v17, 4, v16
  v_add_u32 v22, 512, v22
  v_mul_u32_u24 v16, 4160, v10
  v_lshl_add_u32 v16, v11, 6, v16
  v_and_b32 v17, 3, v12
  v_lshl_add_u32 v16, v17, 2, v16
  v_lshrrev_b32 v17, 2, v12
  v_lshrrev_b32 v18, 3, v11
  v_lshlrev_b32 v18, 1, v18
  v_xor_b32 v17, v17, v18
  v_lshl_add_u32 v23, v17, 4, v16
  v_lshrrev_b32 v16, 3, v8
  v_lshlrev_b32 v16, 1, v16
  v_xor_b32 v16, v16, v9
  v_lshlrev_b32 v16, 4, v16
  v_lshl_add_u32 v16, v8, 6, v16
  s_mul_i32 s50, s20, 2080
  s_mul_i32 s51, s20, 1040
  v_add_u32 v5, s50, v16
  v_add_u32 v6, s51, v16
  v_lshlrev_b32 v1, 4, v0
  s_lshl_b32 s48, s2, 14
  s_add_u32 s49, s48, 8192
  s_waitcnt lgkmcnt(0)
  s_cmp_lg_u32 s20, 0
  s_cbranch_scc1 x1c_w_skip
  v_and_b32 v228, 15, v7
  v_lshlrev_b32 v228, 8, v228
  v_add_u32 v228, 0, v228
  s_mov_b32 s11, 200000
x1c_poll:
  buffer_load_dword v229, v228, s[12:15], 0 offen sc1
  s_waitcnt vmcnt(0)
  v_cmp_le_u32 vcc, 16, v229
  s_nop 1
  s_cmp_eq_u64 vcc, exec
  s_cbranch_scc1 x1c_w_skip
  s_sub_u32 s11, s11, 1
  s_cmp_lg_u32 s11, 0
  s_cbranch_scc1 x1c_poll
x1c_w_skip:
  s_barrier
  buffer_load_dwordx4 v[32:35], v1, s[24:27], s48 offen sc1
  buffer_load_dwordx4 v[36:39], v1, s[24:27], s49 offen sc1
  s_waitcnt vmcnt(0)
  v_lshlrev_b32 v17, 4, v7
  ds_read_b128 v[72:75], v17 offset:32768
  ds_read_b128 v[76:79], v17 offset:33792
  ds_write_b32 v21, v32 offset:34816
  ds_write_b32 v22, v36 offset:34816
  ds_write_b32 v21, v33 offset:35856
  ds_write_b32 v22, v37 offset:35856
  ds_write_b32 v21, v34 offset:36896
  ds_write_b32 v22, v38 offset:36896
  ds_write_b32 v21, v35 offset:37936
  ds_write_b32 v22, v39 offset:37936
  ds_write_b32 v23, v40 offset:51456
  ds_write_b32 v23, v44 offset:59776
  ds_write_b32 v23, v41 offset:52496
  ds_write_b32 v23, v45 offset:60816
  ds_write_b32 v23, v42 offset:53536
  ds_write_b32 v23, v46 offset:61856
  ds_write_b32 v23, v43 offset:54576
  ds_write_b32 v23, v47 offset:62896
  s_mul_i32 s54, s2, 57344
  s_add_u32 s54, s54, 16384
  s_cmp_lt_u32 s20, 4
  s_cbranch_scc1 pf_p2a
  s_mov_b32 s56, s70
  s_mov_b32 s57, s71
  s_mov_b32 s58, 14680064
  s_mov_b32 s59, 0x00020000
  s_sub_u32 s55, s20, 4
  s_mul_i32 s55, s55, 3072
  s_add_u32 s55, s55, s54
  v_lshlrev_b32 v29, 4, v7
  buffer_load_dwordx4 v[232:235], v29, s[56:59], s55 offen offset:0
  buffer_load_dwordx4 v[232:235], v29, s[56:59], s55 offen offset:1024
  buffer_load_dwordx4 v[232:235], v29, s[56:59], s55 offen offset:2048
pf_p2a:
  s_waitcnt lgkmcnt(0)
  s_barrier
  ds_read_b128 v[48:51], v5 offset:34816
  ds_read_b128 v[52:55], v5 offset:35856
  ds_read_b128 v[152:155], v6 offset:51456
  ds_read_b128 v[156:159], v6 offset:59776
  s_waitcnt lgkmcnt(2)
  v_mfma_f32_16x16x32_bf16 v[80:83], v[48:51], v[72:75], 0
  v_mfma_f32_16x16x32_bf16 v[84:87], v[48:51], v[76:79], 0
  v_mfma_f32_16x16x32_bf16 v[88:91], v[52:55], v[72:75], 0
  v_mfma_f32_16x16x32_bf16 v[92:95], v[52:55], v[76:79], 0
  s_waitcnt lgkmcnt(0)
  v_lshlrev_b32 v136, 16, v152
  v_lshlrev_b32 v140, 16, v156
  v_and_b32 v144, 0xffff0000, v152
  v_and_b32 v148, 0xffff0000, v156
  v_lshlrev_b32 v137, 16, v153
  v_lshlrev_b32 v141, 16, v157
  v_and_b32 v145, 0xffff0000, v153
  v_and_b32 v149, 0xffff0000, v157
  v_lshlrev_b32 v138, 16, v154
  v_lshlrev_b32 v142, 16, v158
  v_and_b32 v146, 0xffff0000, v154
  v_and_b32 v150, 0xffff0000, v158
  v_lshlrev_b32 v139, 16, v155
  v_lshlrev_b32 v143, 16, v159
  v_and_b32 v147, 0xffff0000, v155
  v_and_b32 v151, 0xffff0000, v159
  v_pk_mul_f32 v[112:113], v[84:85], v[68:69]
  v_pk_mul_f32 v[116:117], v[80:81], v[68:69]
  v_pk_mul_f32 v[114:115], v[86:87], v[70:71]
  v_pk_mul_f32 v[118:119], v[82:83], v[70:71]
  v_pk_fma_f32 v[96:97], v[80:81], v[64:65], v[112:113]
  v_pk_fma_f32 v[100:101], v[84:85], v[64:65], v[116:117] neg_lo:[0,0,1] neg_hi:[0,0,1]
  v_pk_fma_f32 v[98:99], v[82:83], v[66:67], v[114:115]
  v_pk_fma_f32 v[102:103], v[86:87], v[66:67], v[118:119] neg_lo:[0,0,1] neg_hi:[0,0,1]
  v_pk_mul_f32 v[120:121], v[92:93], v[68:69]
  v_pk_mul_f32 v[124:125], v[88:89], v[68:69]
  v_pk_mul_f32 v[122:123], v[94:95], v[70:71]
  v_pk_mul_f32 v[126:127], v[90:91], v[70:71]
  v_pk_fma_f32 v[104:105], v[88:89], v[64:65], v[120:121]
  v_pk_fma_f32 v[108:109], v[92:93], v[64:65], v[124:125] neg_lo:[0,0,1] neg_hi:[0,0,1]
  v_pk_fma_f32 v[106:107], v[90:91], v[66:67], v[122:123]
  v_pk_fma_f32 v[110:111], v[94:95], v[66:67], v[126:127] neg_lo:[0,0,1] neg_hi:[0,0,1]
  v_cvt_pk_bf16_f32 v128, v96, v100
  v_cvt_pk_bf16_f32 v129, v97, v101
  v_cvt_pk_bf16_f32 v130, v98, v102
  v_cvt_pk_bf16_f32 v131, v99, v103
  v_cvt_pk_bf16_f32 v132, v104, v108
  v_cvt_pk_bf16_f32 v133, v105, v109
  v_cvt_pk_bf16_f32 v134, v106, v110
  v_cvt_pk_bf16_f32 v135, v107, v111
  s_nop 1
  v_mfma_f32_16x16x32_bf16 v[80:83], v[72:75], v[128:131], 0
  v_mfma_f32_16x16x32_bf16 v[84:87], v[76:79], v[128:131], 0
  v_mfma_f32_16x16x32_bf16 v[88:91], v[72:75], v[132:135], 0
  v_mfma_f32_16x16x32_bf16 v[92:95], v[76:79], v[132:135], 0
  s_nop 5
  v_pk_mul_f32 v[112:113], v[84:85], v[140:141]
  v_pk_mul_f32 v[116:117], v[80:81], v[140:141]
  v_pk_mul_f32 v[114:115], v[86:87], v[142:143]
  v_pk_mul_f32 v[118:119], v[82:83], v[142:143]
  v_pk_fma_f32 v[96:97], v[80:81], v[136:137], v[112:113] neg_lo:[0,0,1] neg_hi:[0,0,1]
  v_pk_fma_f32 v[100:101], v[84:85], v[136:137], v[116:117]
  v_pk_fma_f32 v[98:99], v[82:83], v[138:139], v[114:115] neg_lo:[0,0,1] neg_hi:[0,0,1]
  v_pk_fma_f32 v[102:103], v[86:87], v[138:139], v[118:119]
  v_pk_mul_f32 v[120:121], v[92:93], v[148:149]
  v_pk_mul_f32 v[124:125], v[88:89], v[148:149]
  v_pk_mul_f32 v[122:123], v[94:95], v[150:151]
  v_pk_mul_f32 v[126:127], v[90:91], v[150:151]
  v_pk_fma_f32 v[104:105], v[88:89], v[144:145], v[120:121] neg_lo:[0,0,1] neg_hi:[0,0,1]
  v_pk_fma_f32 v[108:109], v[92:93], v[144:145], v[124:125]
  v_pk_fma_f32 v[106:107], v[90:91], v[146:147], v[122:123] neg_lo:[0,0,1] neg_hi:[0,0,1]
  v_pk_fma_f32 v[110:111], v[94:95], v[146:147], v[126:127]
  v_cvt_pk_bf16_f32 v128, v96, -v100
  v_cvt_pk_bf16_f32 v129, v97, -v101
  v_cvt_pk_bf16_f32 v130, v98, -v102
  v_cvt_pk_bf16_f32 v131, v99, -v103
  v_cvt_pk_bf16_f32 v132, v104, -v108
  v_cvt_pk_bf16_f32 v133, v105, -v109
  v_cvt_pk_bf16_f32 v134, v106, -v110
  v_cvt_pk_bf16_f32 v135, v107, -v111
  s_nop 1
  v_mfma_f32_16x16x32_bf16 v[80:83], v[128:131], v[72:75], 0
  v_mfma_f32_16x16x32_bf16 v[84:87], v[128:131], v[76:79], 0
  v_mfma_f32_16x16x32_bf16 v[88:91], v[132:135], v[72:75], 0
  v_mfma_f32_16x16x32_bf16 v[92:95], v[132:135], v[76:79], 0
  s_nop 5
  v_pk_mul_f32 v[112:113], v[84:85], v[68:69]
  v_pk_mul_f32 v[116:117], v[80:81], v[68:69]
  v_pk_mul_f32 v[114:115], v[86:87], v[70:71]
  v_pk_mul_f32 v[118:119], v[82:83], v[70:71]
  v_pk_fma_f32 v[96:97], v[80:81], v[64:65], v[112:113]
  v_pk_fma_f32 v[100:101], v[84:85], v[64:65], v[116:117] neg_lo:[0,0,1] neg_hi:[0,0,1]
  v_pk_fma_f32 v[98:99], v[82:83], v[66:67], v[114:115]
  v_pk_fma_f32 v[102:103], v[86:87], v[66:67], v[118:119] neg_lo:[0,0,1] neg_hi:[0,0,1]
  v_pk_mul_f32 v[120:121], v[92:93], v[68:69]
  v_pk_mul_f32 v[124:125], v[88:89], v[68:69]
  v_pk_mul_f32 v[122:123], v[94:95], v[70:71]
  v_pk_mul_f32 v[126:127], v[90:91], v[70:71]
  v_pk_fma_f32 v[104:105], v[88:89], v[64:65], v[120:121]
  v_pk_fma_f32 v[108:109], v[92:93], v[64:65], v[124:125] neg_lo:[0,0,1] neg_hi:[0,0,1]
  v_pk_fma_f32 v[106:107], v[90:91], v[66:67], v[122:123]
  v_pk_fma_f32 v[110:111], v[94:95], v[66:67], v[126:127] neg_lo:[0,0,1] neg_hi:[0,0,1]
  v_cvt_pk_bf16_f32 v128, v96, v100
  v_cvt_pk_bf16_f32 v129, v97, v101
  v_cvt_pk_bf16_f32 v130, v98, v102
  v_cvt_pk_bf16_f32 v131, v99, v103
  v_cvt_pk_bf16_f32 v132, v104, v108
  v_cvt_pk_bf16_f32 v133, v105, v109
  v_cvt_pk_bf16_f32 v134, v106, v110
  v_cvt_pk_bf16_f32 v135, v107, v111
  s_nop 1
  v_mfma_f32_16x16x32_bf16 v[80:83], v[72:75], v[128:131], 0
  v_mfma_f32_16x16x32_bf16 v[84:87], v[76:79], v[128:131], 0
  v_mfma_f32_16x16x32_bf16 v[88:91], v[72:75], v[132:135], 0
  v_mfma_f32_16x16x32_bf16 v[92:95], v[76:79], v[132:135], 0
  s_nop 5
  v_cvt_pk_bf16_f32 v128, v80, -v84
  v_cvt_pk_bf16_f32 v129, v81, -v85
  v_cvt_pk_bf16_f32 v130, v82, -v86
  v_cvt_pk_bf16_f32 v131, v83, -v87
  v_cvt_pk_bf16_f32 v132, v88, -v92
  v_cvt_pk_bf16_f32 v133, v89, -v93
  v_cvt_pk_bf16_f32 v134, v90, -v94
  v_cvt_pk_bf16_f32 v135, v91, -v95
  ds_write_b128 v5, v[128:131] offset:34816
  ds_write_b128 v5, v[132:135] offset:35856
  s_waitcnt lgkmcnt(0)
  s_barrier
  ds_read_b32 v32, v21 offset:34816
  ds_read_b32 v36, v22 offset:34816
  ds_read_b32 v33, v21 offset:35856
  ds_read_b32 v37, v22 offset:35856
  ds_read_b32 v34, v21 offset:36896
  ds_read_b32 v38, v22 offset:36896
  ds_read_b32 v35, v21 offset:37936
  ds_read_b32 v39, v22 offset:37936
  v_bfe_u32 v16, v0, 2, 4
  v_lshrrev_b32 v17, 6, v0
  v_lshl_add_u32 v16, v16, 4, v17
  v_lshlrev_b32 v16, 14, v16
  v_and_b32 v17, 3, v0
  v_lshl_add_u32 v16, v17, 4, v16
  s_lshl_b32 s50, s46, 11
  s_lshl_b32 s51, s47, 6
  s_add_u32 s50, s50, s51
  s_add_u32 s51, s50, 131072
  s_waitcnt lgkmcnt(0)
  buffer_store_dwordx4 v[32:35], v16, s[28:31], s50 offen sc1
  buffer_store_dwordx4 v[36:39], v16, s[28:31], s51 offen sc1
  s_and_b32 s54, s2, 15
  s_waitcnt vmcnt(0)
  s_barrier
  s_cmp_lg_u32 s20, 0
  s_cbranch_scc1 x2_arr_skip
  s_lshl_b32 s10, s54, 8
  s_add_u32 s10, s10, 4096
  v_mov_b32 v228, s10
  v_mov_b32 v229, 1
  s_mov_b64 s[16:17], exec
  s_mov_b64 exec, 1
  buffer_atomic_add v229, v228, s[12:15], 0 offen sc1
  s_mov_b64 exec, s[16:17]
x2_arr_skip:
  s_add_u32 s24, s82, 4194304
  s_addc_u32 s25, s83, 0
  s_mov_b32 s26, 4194304
  s_mov_b32 s27, 0x00020000
  s_mov_b32 s28, s64
  s_mov_b32 s29, s65
  s_mov_b32 s30, 4194304
  s_mov_b32 s31, 0x00020000
  s_add_u32 s32, s82, 8388608
  s_addc_u32 s33, s83, 0
  s_mov_b32 s34, 4194304
  s_mov_b32 s35, 0x00020000
  s_add_u32 s36, s82, 12582912
  s_addc_u32 s37, s83, 0
  s_mov_b32 s38, 4194304
  s_mov_b32 s39, 0x00020000
  s_lshl_b32 s49, s20, 8
  s_add_u32 s49, s49, s2
  s_lshl_b32 s49, s49, 11
  v_lshlrev_b32 v4, 6, v8
  v_lshl_add_u32 v4, v9, 4, v4
  buffer_load_dwordx4 v[192:195], v4, s[28:31], s49 offen offset:0
  buffer_load_dwordx4 v[196:199], v4, s[28:31], s49 offen offset:1024
  s_mov_b32 s63, s49
  s_add_u32 s56, s82, 25165824
  s_addc_u32 s57, s83, 0
  s_mov_b32 s58, 4194304
  s_mov_b32 s59, 0x00020000
  v_mov_b32 v200, -1
  v_mov_b32 v201, -1
  v_mov_b32 v202, -1
  v_mov_b32 v203, -1
  v_lshlrev_b32 v2, 4, v0
  s_lshl_b32 s54, s2, 14
  buffer_store_dwordx4 v[200:203], v2, s[56:59], s54 offen sc1
  s_add_u32 s54, s54, 8192
  buffer_store_dwordx4 v[200:203], v2, s[56:59], s54 offen sc1
  s_mul_i32 s54, s2, 57344
  s_add_u32 s54, s54, 28672
  s_cmp_lt_u32 s20, 4
  s_cbranch_scc1 pf_p3a
  s_mov_b32 s56, s70
  s_mov_b32 s57, s71
  s_mov_b32 s58, 14680064
  s_mov_b32 s59, 0x00020000
  s_sub_u32 s55, s20, 4
  s_mul_i32 s55, s55, 4096
  s_add_u32 s55, s55, s54
  v_lshlrev_b32 v29, 4, v7
  buffer_load_dwordx4 v[232:235], v29, s[56:59], s55 offen offset:0
  buffer_load_dwordx4 v[232:235], v29, s[56:59], s55 offen offset:1024
  buffer_load_dwordx4 v[232:235], v29, s[56:59], s55 offen offset:2048
  buffer_load_dwordx4 v[232:235], v29, s[56:59], s55 offen offset:3072
pf_p3a:
  s_lshr_b32 s46, s2, 3
  s_cmp_lt_u32 s46, 28
  s_cselect_b32 s62, 1, 0
  s_mul_i32 s47, s46, 37
  s_lshr_b32 s47, s47, 8
  s_mul_i32 s48, s47, 7
  s_sub_u32 s48, s46, s48
  s_and_b32 s49, s2, 7
  s_lshr_b32 s50, s49, 1
  s_mul_i32 s50, s50, 7
  s_add_u32 s60, s50, s48
  s_and_b32 s49, s49, 1
  s_lshl_b32 s49, s49, 2
  s_add_u32 s61, s49, s47
  s_sub_u32 s50, s20, 4
  s_lshl_b32 s49, s50, 2
  s_add_u32 s49, s49, 0
  v_lshrrev_b32 v14, 4, v7
  v_add_u32 v14, s49, v14
  v_and_b32 v15, 3, v14
  v_lshlrev_b32 v15, 2, v15
  v_bfe_u32 v16, v14, 3, 1
  v_lshl_add_u32 v15, v16, 1, v15
  v_and_b32 v16, 15, v7
  v_xor_b32 v16, v16, v15
  v_lshrrev_b32 v17, 3, v14
  v_and_b32 v18, 7, v14
  v_lshl_add_u32 v17, v18, 8, v17
  v_mul_u32_u24 v17, 7168, v17
  v_lshl_add_u32 v17, v16, 4, v17
  s_lshl_b32 s49, s60, 8
  v_add_u32 v224, s49, v17
  s_lshl_b32 s49, s50, 2
  s_add_u32 s49, s49, 16
  v_lshrrev_b32 v14, 4, v7
  v_add_u32 v14, s49, v14
  v_and_b32 v15, 3, v14
  v_lshlrev_b32 v15, 2, v15
  v_bfe_u32 v16, v14, 3, 1
  v_lshl_add_u32 v15, v16, 1, v15
  v_and_b32 v16, 15, v7
  v_xor_b32 v16, v16, v15
  v_lshrrev_b32 v17, 3, v14
  v_and_b32 v18, 7, v14
  v_lshl_add_u32 v17, v18, 8, v17
  v_mul_u32_u24 v17, 7168, v17
  v_lshl_add_u32 v17, v16, 4, v17
  s_lshl_b32 s49, s60, 8
  v_add_u32 v225, s49, v17
  s_lshl_b32 s49, s50, 2
  s_add_u32 s49, s49, 32
  v_lshrrev_b32 v14, 4, v7
  v_add_u32 v14, s49, v14
  v_and_b32 v15, 3, v14
  v_lshlrev_b32 v15, 2, v15
  v_bfe_u32 v16, v14, 3, 1
  v_lshl_add_u32 v15, v16, 1, v15
  v_and_b32 v16, 15, v7
  v_xor_b32 v16, v16, v15
  v_lshrrev_b32 v17, 3, v14
  v_and_b32 v18, 7, v14
  v_lshl_add_u32 v17, v18, 8, v17
  v_mul_u32_u24 v17, 7168, v17
  v_lshl_add_u32 v17, v16, 4, v17
  s_lshl_b32 s49, s60, 8
  v_add_u32 v226, s49, v17
  s_lshl_b32 s49, s50, 2
  s_add_u32 s49, s49, 48
  v_lshrrev_b32 v14, 4, v7
  v_add_u32 v14, s49, v14
  v_and_b32 v15, 3, v14
  v_lshlrev_b32 v15, 2, v15
  v_bfe_u32 v16, v14, 3, 1
  v_lshl_add_u32 v15, v16, 1, v15
  v_and_b32 v16, 15, v7
  v_xor_b32 v16, v16, v15
  v_lshrrev_b32 v17, 3, v14
  v_and_b32 v18, 7, v14
  v_lshl_add_u32 v17, v18, 8, v17
  v_mul_u32_u24 v17, 7168, v17
  v_lshl_add_u32 v17, v16, 4, v17
  s_lshl_b32 s49, s60, 8
  v_add_u32 v227, s49, v17
  s_sub_u32 s50, s20, 4
  s_lshl_b32 s5, s50, 10
  s_add_u32 s7, s5, 131072
  s_mov_b32 s4, 0
  s_mov_b32 s9, 57344
  v_and_b32 v10, 255, v0
  v_lshrrev_b32 v11, 8, v0
  v_bfe_u32 v12, v10, 2, 4
  v_lshrrev_b32 v13, 6, v10
  v_and_b32 v14, 3, v10
  v_lshl_add_u32 v13, v13, 2, v14
  v_lshrrev_b32 v15, 2, v12
  v_lshlrev_b32 v15, 3, v15
  v_and_b32 v16, 3, v12
  v_add_u32 v15, v15, v16
  v_lshl_add_u32 v16, v11, 2, v15
  v_mul_u32_u24 v17, v16, v13
  v_and_b32 v20, 31, v17
  v_cvt_f32_u32 v20, v20
  v_mul_f32 v20, 0x3d000000, v20
  v_cos_f32 v18, v20
  v_sin_f32 v19, v20
  v_lshlrev_b32 v22, 2, v10
  v_lshl_add_u32 v22, v11, 11, v22
  v_add_u32 v22, 98304, v22
  v_cvt_pk_bf16_f32 v23, v18, -v19
  v_cvt_pk_bf16_f32 v24, v19, v18
  ds_write_b32 v22, v23
  ds_write_b32 v22, v24 offset:1024
  v_lshl_add_u32 v17, v11, 4, v13
  v_add_u32 v21, 0, v12
  v_mul_u32_u24 v21, v21, v17
  v_and_b32 v20, 31, v21
  v_cvt_f32_u32 v20, v20
  v_mul_f32 v20, 0x3d000000, v20
  v_cos_f32 v18, v20
  v_sin_f32 v19, v20
  v_add_f32 v18, v18, v18
  v_mul_f32 v19, -2.0, v19
  v_cvt_pk_bf16_f32 v23, v18, v19
  ds_write_b32 v22, v23 offset:4096
  v_add_u32 v21, 16, v12
  v_mul_u32_u24 v21, v21, v17
  v_and_b32 v20, 31, v21
  v_cvt_f32_u32 v20, v20
  v_mul_f32 v20, 0x3d000000, v20
  v_cos_f32 v18, v20
  v_sin_f32 v19, v20
  v_add_f32 v18, v18, v18
  v_mul_f32 v19, -2.0, v19
  v_cvt_pk_bf16_f32 v23, v18, v19
  ds_write_b32 v22, v23 offset:5120
  v_lshlrev_b32 v23, 2, v10
  v_lshl_add_u32 v23, v11, 12, v23
  v_add_u32 v23, 106496, v23
  v_add_u32 v21, 0, v15
  v_mul_u32_u24 v21, v21, v17
  v_and_b32 v20, 1023, v21
  v_cvt_f32_u32 v20, v20
  v_mul_f32 v20, 0x3a800000, v20
  v_cos_f32 v18, v20
  v_sin_f32 v19, v20
  ds_write_b32 v23, v18 offset:0
  ds_write_b32 v23, v19 offset:1024
  v_add_u32 v21, 4, v15
  v_mul_u32_u24 v21, v21, v17
  v_and_b32 v20, 1023, v21
  v_cvt_f32_u32 v20, v20
  v_mul_f32 v20, 0x3a800000, v20
  v_cos_f32 v18, v20
  v_sin_f32 v19, v20
  ds_write_b32 v23, v18 offset:2048
  ds_write_b32 v23, v19 offset:3072
  v_lshrrev_b32 v10, 1, v8
  v_lshlrev_b32 v10, 8, v10
  v_add_u32 v10, s2, v10
  v_lshlrev_b32 v11, 1, v9
  v_add_u32 v12, 1, v11
  v_mul_u32_u24 v11, v10, v11
  v_mul_u32_u24 v12, v10, v12
  v_and_b32 v17, 2047, v11
  v_cvt_f32_u32 v17, v17
  v_mul_f32 v17, 0x3a000000, v17
  v_cos_f32 v13, v17
  v_sin_f32 v14, v17
  v_and_b32 v17, 2047, v12
  v_cvt_f32_u32 v17, v17
  v_mul_f32 v17, 0x3a000000, v17
  v_cos_f32 v15, v17
  v_sin_f32 v16, v17
  v_and_b32 v17, 1, v8
  v_cmp_eq_u32 vcc, 1, v17
  s_nop 1
  v_mul_f32 v13, 0x35000000, v13
  v_mul_f32 v14, 0x35000000, v14
  v_cndmask_b32 v18, v13, v14, vcc
  v_cndmask_b32 v19, v14, v13, vcc
  v_xor_b32 v17, 0x80000000, v19
  v_cndmask_b32 v19, v17, v19, vcc
  v_cvt_pk_bf16_f32 v30, v18, v19
  v_mul_f32 v15, 0x35000000, v15
  v_mul_f32 v16, 0x35000000, v16
  v_cndmask_b32 v18, v15, v16, vcc
  v_cndmask_b32 v19, v16, v15, vcc
  v_xor_b32 v17, 0x80000000, v19
  v_cndmask_b32 v19, v17, v19, vcc
  v_cvt_pk_bf16_f32 v31, v18, v19
  v_lshlrev_b32 v1, 12, v9
  v_lshl_add_u32 v1, v8, 2, v1
  s_lshl_b32 s46, s2, 14
  s_and_b32 s47, s20, 1
  s_lshl_b32 s47, s47, 6
  s_lshr_b32 s48, s20, 1
  s_lshl_b32 s48, s48, 9
  s_add_u32 s46, s46, s47
  s_add_u32 s44, s46, s48
  s_lshl_b32 s47, s47, 4
  s_lshr_b32 s48, s48, 1
  s_add_u32 s45, s47, s48
  s_waitcnt lgkmcnt(0)
  s_cmp_lg_u32 s20, 0
  s_cbranch_scc1 x2c_w_skip
  v_and_b32 v228, 15, v7
  v_lshlrev_b32 v228, 8, v228
  v_add_u32 v228, 4096, v228
  s_mov_b32 s11, 200000
x2c_poll:
  buffer_load_dword v229, v228, s[12:15], 0 offen sc1
  s_waitcnt vmcnt(0)
  v_cmp_le_u32 vcc, 16, v229
  s_nop 1
  s_cmp_eq_u64 vcc, exec
  s_cbranch_scc1 x2c_w_skip
  s_sub_u32 s11, s11, 1
  s_cmp_lg_u32 s11, 0
  s_cbranch_scc1 x2c_poll
x2c_w_skip:
  s_barrier
  v_lshlrev_b32 v3, 12, v9
  v_lshl_add_u32 v3, v8, 4, v3
  v_add_u32 v3, s45, v3
  v_add_u32 v3, 114688, v3
  v_lshlrev_b32 v6, 4, v7
  v_add_u32 v6, 98304, v6
  ds_read_b128 v[96:99], v6 offset:0
  ds_read_b128 v[100:103], v6 offset:1024
  ds_read_b128 v[104:107], v6 offset:2048
  ds_read_b128 v[108:111], v6 offset:3072
  ds_read_b128 v[112:115], v6 offset:4096
  ds_read_b128 v[116:119], v6 offset:5120
  ds_read_b128 v[120:123], v6 offset:6144
  ds_read_b128 v[124:127], v6 offset:7168
  s_waitcnt lgkmcnt(0)
  ds_read_b128 v[128:131], v6 offset:8192
  ds_read_b128 v[132:135], v6 offset:9216
  ds_read_b128 v[136:139], v6 offset:10240
  ds_read_b128 v[140:143], v6 offset:11264
  ds_read_b128 v[144:147], v6 offset:12288
  ds_read_b128 v[148:151], v6 offset:13312
  ds_read_b128 v[152:155], v6 offset:14336
  ds_read_b128 v[156:159], v6 offset:15360
  buffer_load_dword v32, v1, s[24:27], s44 offen offset:0 sc1
  buffer_load_dword v33, v1, s[24:27], s44 offen offset:2048 sc1
  buffer_load_dword v34, v1, s[24:27], s44 offen offset:128 sc1
  buffer_load_dword v35, v1, s[24:27], s44 offen offset:2176 sc1
  buffer_load_dword v36, v1, s[24:27], s44 offen offset:256 sc1
  buffer_load_dword v37, v1, s[24:27], s44 offen offset:2304 sc1
  buffer_load_dword v38, v1, s[24:27], s44 offen offset:384 sc1
  buffer_load_dword v39, v1, s[24:27], s44 offen offset:2432 sc1
  s_waitcnt vmcnt(0)
  s_mul_i32 s54, s2, 57344
  s_add_u32 s54, s54, 45056
  s_cmp_lt_u32 s20, 4
  s_cbranch_scc1 pf_p3b
  s_mov_b32 s56, s70
  s_mov_b32 s57, s71
  s_mov_b32 s58, 14680064
  s_mov_b32 s59, 0x00020000
  s_sub_u32 s55, s20, 4
  s_mul_i32 s55, s55, 3072
  s_add_u32 s55, s55, s54
  v_lshlrev_b32 v29, 4, v7
  buffer_load_dwordx4 v[232:235], v29, s[56:59], s55 offen offset:0
  buffer_load_dwordx4 v[232:235], v29, s[56:59], s55 offen offset:1024
  buffer_load_dwordx4 v[232:235], v29, s[56:59], s55 offen offset:2048
pf_p3b:
  v_mfma_f32_16x16x16_bf16 v[40:43], v[30:31], v[32:33], 0
  v_mfma_f32_16x16x16_bf16 v[44:47], v[30:31], v[34:35], 0
  v_mfma_f32_16x16x16_bf16 v[48:51], v[30:31], v[36:37], 0
  v_mfma_f32_16x16x16_bf16 v[52:55], v[30:31], v[38:39], 0
  s_nop 4
  v_cvt_pk_bf16_f32 v56, v40, v41
  v_cvt_pk_bf16_f32 v57, v44, v45
  v_cvt_pk_bf16_f32 v58, v48, v49
  v_cvt_pk_bf16_f32 v59, v52, v53
  v_cvt_pk_bf16_f32 v60, v42, v43
  v_cvt_pk_bf16_f32 v61, v46, v47
  v_cvt_pk_bf16_f32 v62, v50, v51
  v_cvt_pk_bf16_f32 v63, v54, v55
  ds_write_b128 v3, v[56:59]
  ds_write_b128 v3, v[60:63] offset:2048
  s_waitcnt lgkmcnt(0)
  s_barrier
  v_lshlrev_b32 v5, 8, v9
  v_lshl_add_u32 v5, v8, 4, v5
  s_lshl_b32 s47, s20, 11
  s_add_u32 s47, s47, 114688
  v_add_u32 v5, s47, v5
  ds_read_b128 v[32:35], v5
  ds_read_b128 v[36:39], v5 offset:1024
  s_waitcnt lgkmcnt(0)
  v_readlane_b32 s50, v32, 0
  v_writelane_b32 v32, 0, 0
  s_nop 1
  s_lshl_b32 s50, s50, 16
  v_mfma_f32_16x16x32_bf16 v[160:163], v[32:35], v[96:99], 0
  v_mfma_f32_16x16x32_bf16 v[164:167], v[32:35], v[100:103], 0
  v_mfma_f32_16x16x32_bf16 v[168:171], v[32:35], v[104:107], 0
  v_mfma_f32_16x16x32_bf16 v[172:175], v[32:35], v[108:111], 0
  v_mfma_f32_16x16x32_bf16 v[176:179], v[36:39], v[96:99], 0
  v_mfma_f32_16x16x32_bf16 v[180:183], v[36:39], v[100:103], 0
  v_mfma_f32_16x16x32_bf16 v[184:187], v[36:39], v[104:107], 0
  v_mfma_f32_16x16x32_bf16 v[188:191], v[36:39], v[108:111], 0
  v_mov_b32 v60, s50
  v_xor_b32 v61, 0x80000000, v60
  v_mov_b32 v62, v60
  v_mov_b32 v63, v61
  s_nop 1
  v_pk_mul_f32 v[80:81], v[164:165], v[132:133]
  v_pk_mul_f32 v[84:85], v[160:161], v[132:133]
  v_pk_mul_f32 v[82:83], v[166:167], v[134:135]
  v_pk_mul_f32 v[86:87], v[162:163], v[134:135]
  v_pk_fma_f32 v[40:41], v[160:161], v[128:129], v[80:81] neg_lo:[0,0,1] neg_hi:[0,0,1]
  v_pk_fma_f32 v[44:45], v[164:165], v[128:129], v[84:85]
  v_pk_fma_f32 v[42:43], v[162:163], v[130:131], v[82:83] neg_lo:[0,0,1] neg_hi:[0,0,1]
  v_pk_fma_f32 v[46:47], v[166:167], v[130:131], v[86:87]
  v_cvt_pk_bf16_f32 v64, v40, v44
  v_cvt_pk_bf16_f32 v65, v41, v45
  v_cvt_pk_bf16_f32 v66, v42, v46
  v_cvt_pk_bf16_f32 v67, v43, v47
  v_pk_mul_f32 v[80:81], v[172:173], v[140:141]
  v_pk_mul_f32 v[84:85], v[168:169], v[140:141]
  v_pk_mul_f32 v[82:83], v[174:175], v[142:143]
  v_pk_mul_f32 v[86:87], v[170:171], v[142:143]
  v_pk_fma_f32 v[40:41], v[168:169], v[136:137], v[80:81] neg_lo:[0,0,1] neg_hi:[0,0,1]
  v_pk_fma_f32 v[44:45], v[172:173], v[136:137], v[84:85]
  v_pk_fma_f32 v[42:43], v[170:171], v[138:139], v[82:83] neg_lo:[0,0,1] neg_hi:[0,0,1]
  v_pk_fma_f32 v[46:47], v[174:175], v[138:139], v[86:87]
  v_cvt_pk_bf16_f32 v68, v40, v44
  v_cvt_pk_bf16_f32 v69, v41, v45
  v_cvt_pk_bf16_f32 v70, v42, v46
  v_cvt_pk_bf16_f32 v71, v43, v47
  v_pk_mul_f32 v[80:81], v[180:181], v[148:149]
  v_pk_mul_f32 v[84:85], v[176:177], v[148:149]
  v_pk_mul_f32 v[82:83], v[182:183], v[150:151]
  v_pk_mul_f32 v[86:87], v[178:179], v[150:151]
  v_pk_fma_f32 v[40:41], v[176:177], v[144:145], v[80:81] neg_lo:[0,0,1] neg_hi:[0,0,1]
  v_pk_fma_f32 v[44:45], v[180:181], v[144:145], v[84:85]
  v_pk_fma_f32 v[42:43], v[178:179], v[146:147], v[82:83] neg_lo:[0,0,1] neg_hi:[0,0,1]
  v_pk_fma_f32 v[46:47], v[182:183], v[146:147], v[86:87]
  v_cvt_pk_bf16_f32 v72, v40, v44
  v_cvt_pk_bf16_f32 v73, v41, v45
  v_cvt_pk_bf16_f32 v74, v42, v46
  v_cvt_pk_bf16_f32 v75, v43, v47
  v_pk_mul_f32 v[80:81], v[188:189], v[156:157]
  v_pk_mul_f32 v[84:85], v[184:185], v[156:157]
  v_pk_mul_f32 v[82:83], v[190:191], v[158:159]
  v_pk_mul_f32 v[86:87], v[186:187], v[158:159]
  v_pk_fma_f32 v[40:41], v[184:185], v[152:153], v[80:81] neg_lo:[0,0,1] neg_hi:[0,0,1]
  v_pk_fma_f32 v[44:45], v[188:189], v[152:153], v[84:85]
  v_pk_fma_f32 v[42:43], v[186:187], v[154:155], v[82:83] neg_lo:[0,0,1] neg_hi:[0,0,1]
  v_pk_fma_f32 v[46:47], v[190:191], v[154:155], v[86:87]
  v_cvt_pk_bf16_f32 v76, v40, v44
  v_cvt_pk_bf16_f32 v77, v41, v45
  v_cvt_pk_bf16_f32 v78, v42, v46
  v_cvt_pk_bf16_f32 v79, v43, v47
  s_nop 1
  v_mfma_f32_16x16x32_bf16 v[160:163], v[64:67], v[112:115], v[60:63]
  v_mfma_f32_16x16x32_bf16 v[164:167], v[68:71], v[112:115], v[60:63]
  v_mfma_f32_16x16x32_bf16 v[168:171], v[64:67], v[116:119], v[60:63]
  v_mfma_f32_16x16x32_bf16 v[172:175], v[68:71], v[116:119], v[60:63]
  v_mfma_f32_16x16x32_bf16 v[160:163], v[72:75], v[120:123], v[160:163]
  v_mfma_f32_16x16x32_bf16 v[164:167], v[76:79], v[120:123], v[164:167]
  v_mfma_f32_16x16x32_bf16 v[168:171], v[72:75], v[124:127], v[168:171]
  v_mfma_f32_16x16x32_bf16 v[172:175], v[76:79], v[124:127], v[172:175]
  s_nop 7
  v_lshlrev_b32 v64, 16, v192
  v_and_b32 v65, 0xffff0000, v192
  v_pk_add_f32 v[64:65], v[64:65], v[160:161]
  v_cvt_pk_bf16_f32 v32, v64, v65
  v_lshlrev_b32 v66, 16, v193
  v_and_b32 v67, 0xffff0000, v193
  v_pk_add_f32 v[66:67], v[66:67], v[162:163]
  v_cvt_pk_bf16_f32 v33, v66, v67
  v_lshlrev_b32 v68, 16, v194
  v_and_b32 v69, 0xffff0000, v194
  v_pk_add_f32 v[68:69], v[68:69], v[164:165]
  v_cvt_pk_bf16_f32 v34, v68, v69
  v_lshlrev_b32 v70, 16, v195
  v_and_b32 v71, 0xffff0000, v195
  v_pk_add_f32 v[70:71], v[70:71], v[166:167]
  v_cvt_pk_bf16_f32 v35, v70, v71
  v_lshlrev_b32 v64, 16, v196
  v_and_b32 v65, 0xffff0000, v196
  v_pk_add_f32 v[64:65], v[64:65], v[168:169]
  v_cvt_pk_bf16_f32 v36, v64, v65
  v_lshlrev_b32 v66, 16, v197
  v_and_b32 v67, 0xffff0000, v197
  v_pk_add_f32 v[66:67], v[66:67], v[170:171]
  v_cvt_pk_bf16_f32 v37, v66, v67
  v_lshlrev_b32 v68, 16, v198
  v_and_b32 v69, 0xffff0000, v198
  v_pk_add_f32 v[68:69], v[68:69], v[172:173]
  v_cvt_pk_bf16_f32 v38, v68, v69
  v_lshlrev_b32 v70, 16, v199
  v_and_b32 v71, 0xffff0000, v199
  v_pk_add_f32 v[70:71], v[70:71], v[174:175]
  v_cvt_pk_bf16_f32 v39, v70, v71
  buffer_store_dwordx4 v[32:35], v4, s[32:35], s63 offen offset:0 sc1
  buffer_store_dwordx4 v[36:39], v4, s[32:35], s63 offen offset:1024 sc1
  v_lshlrev_b32 v40, 16, v32
  v_and_b32 v41, 0xffff0000, v32
  v_lshlrev_b32 v42, 16, v33
  v_and_b32 v43, 0xffff0000, v33
  v_lshlrev_b32 v44, 16, v34
  v_and_b32 v45, 0xffff0000, v34
  v_lshlrev_b32 v46, 16, v35
  v_and_b32 v47, 0xffff0000, v35
  v_lshlrev_b32 v48, 16, v36
  v_and_b32 v49, 0xffff0000, v36
  v_lshlrev_b32 v50, 16, v37
  v_and_b32 v51, 0xffff0000, v37
  v_lshlrev_b32 v52, 16, v38
  v_and_b32 v53, 0xffff0000, v38
  v_lshlrev_b32 v54, 16, v39
  v_and_b32 v55, 0xffff0000, v39
  v_readlane_b32 s50, v40, 0
  s_nop 1
  v_pk_add_f32 v[40:41], v[40:41], s[50:51] op_sel_hi:[1,0] neg_lo:[0,1] neg_hi:[0,1]
  v_pk_add_f32 v[42:43], v[42:43], s[50:51] op_sel_hi:[1,0] neg_lo:[0,1] neg_hi:[0,1]
  v_pk_add_f32 v[44:45], v[44:45], s[50:51] op_sel_hi:[1,0] neg_lo:[0,1] neg_hi:[0,1]
  v_pk_add_f32 v[46:47], v[46:47], s[50:51] op_sel_hi:[1,0] neg_lo:[0,1] neg_hi:[0,1]
  v_pk_add_f32 v[48:49], v[48:49], s[50:51] op_sel_hi:[1,0] neg_lo:[0,1] neg_hi:[0,1]
  v_pk_add_f32 v[50:51], v[50:51], s[50:51] op_sel_hi:[1,0] neg_lo:[0,1] neg_hi:[0,1]
  v_pk_add_f32 v[52:53], v[52:53], s[50:51] op_sel_hi:[1,0] neg_lo:[0,1] neg_hi:[0,1]
  v_pk_add_f32 v[54:55], v[54:55], s[50:51] op_sel_hi:[1,0] neg_lo:[0,1] neg_hi:[0,1]
  v_pk_add_f32 v[64:65], v[40:41], v[42:43]
  v_pk_add_f32 v[66:67], v[48:49], v[50:51]
  v_pk_mul_f32 v[68:69], v[40:41], v[40:41]
  v_pk_add_f32 v[64:65], v[64:65], v[44:45]
  v_pk_add_f32 v[66:67], v[66:67], v[52:53]
  v_pk_fma_f32 v[68:69], v[42:43], v[42:43], v[68:69]
  v_pk_add_f32 v[64:65], v[64:65], v[46:47]
  v_pk_add_f32 v[66:67], v[66:67], v[54:55]
  v_pk_fma_f32 v[68:69], v[44:45], v[44:45], v[68:69]
  v_pk_fma_f32 v[68:69], v[46:47], v[46:47], v[68:69]
  v_pk_fma_f32 v[68:69], v[48:49], v[48:49], v[68:69]
  v_pk_fma_f32 v[68:69], v[50:51], v[50:51], v[68:69]
  v_pk_fma_f32 v[68:69], v[52:53], v[52:53], v[68:69]
  v_pk_fma_f32 v[68:69], v[54:55], v[54:55], v[68:69]
  v_add_f32 v64, v64, v65
  v_add_f32 v66, v66, v67
  v_add_f32 v64, v64, v66
  v_add_f32 v68, v68, v69
  s_nop 0
  v_add_f32_dpp v64, v64, v64 row_ror:8 row_mask:0xf bank_mask:0xf
  v_add_f32_dpp v68, v68, v68 row_ror:8 row_mask:0xf bank_mask:0xf
  s_nop 0
  v_add_f32_dpp v64, v64, v64 row_ror:4 row_mask:0xf bank_mask:0xf
  v_add_f32_dpp v68, v68, v68 row_ror:4 row_mask:0xf bank_mask:0xf
  s_nop 0
  v_add_f32_dpp v64, v64, v64 row_ror:2 row_mask:0xf bank_mask:0xf
  v_add_f32_dpp v68, v68, v68 row_ror:2 row_mask:0xf bank_mask:0xf
  s_nop 0
  v_add_f32_dpp v64, v64, v64 row_ror:1 row_mask:0xf bank_mask:0xf
  v_add_f32_dpp v68, v68, v68 row_ror:1 row_mask:0xf bank_mask:0xf
  s_nop 0
  v_add_f32_dpp v64, v64, v64 row_bcast:15 row_mask:0xa bank_mask:0xf
  v_add_f32_dpp v68, v68, v68 row_bcast:15 row_mask:0xa bank_mask:0xf
  s_nop 0
  v_add_f32_dpp v64, v64, v64 row_bcast:31 row_mask:0xc bank_mask:0xf
  v_add_f32_dpp v68, v68, v68 row_bcast:31 row_mask:0xc bank_mask:0xf
  s_nop 0
  v_readlane_b32 s52, v64, 63
  v_readlane_b32 s53, v68, 63
  s_nop 0
  v_mov_b32 v64, 0x3a800000
  v_mul_f32 v65, s52, v64
  v_mul_f32 v66, s53, v64
  v_fma_f32 v66, -v65, v65, v66
  v_max_f32 v66, 0, v66
  v_add_f32 v66, 0x3727c5ac, v66
  v_rsq_f32 v68, v66
  s_nop 0
  v_mul_f32 v72, -v65, v68
  v_pk_fma_f32 v[40:41], v[40:41], v[68:69], v[72:73] op_sel_hi:[1,0,0]
  v_pk_fma_f32 v[42:43], v[42:43], v[68:69], v[72:73] op_sel_hi:[1,0,0]
  v_pk_fma_f32 v[44:45], v[44:45], v[68:69], v[72:73] op_sel_hi:[1,0,0]
  v_pk_fma_f32 v[46:47], v[46:47], v[68:69], v[72:73] op_sel_hi:[1,0,0]
  v_pk_fma_f32 v[48:49], v[48:49], v[68:69], v[72:73] op_sel_hi:[1,0,0]
  v_pk_fma_f32 v[50:51], v[50:51], v[68:69], v[72:73] op_sel_hi:[1,0,0]
  v_pk_fma_f32 v[52:53], v[52:53], v[68:69], v[72:73] op_sel_hi:[1,0,0]
  v_pk_fma_f32 v[54:55], v[54:55], v[68:69], v[72:73] op_sel_hi:[1,0,0]
  v_cvt_pk_bf16_f32 v72, v40, v41
  v_cvt_pk_bf16_f32 v73, v42, v43
  v_cvt_pk_bf16_f32 v74, v44, v45
  v_cvt_pk_bf16_f32 v75, v46, v47
  v_cvt_pk_bf16_f32 v76, v48, v49
  v_cvt_pk_bf16_f32 v77, v50, v51
  v_cvt_pk_bf16_f32 v78, v52, v53
  v_cvt_pk_bf16_f32 v79, v54, v55
  v_mul_u32_u24 v3, 80, v8
  v_lshl_add_u32 v3, v9, 4, v3
  s_mul_i32 s47, s20, 2624
  s_add_u32 s47, s47, 131072
  v_add_u32 v3, s47, v3
  ds_write_b128 v3, v[72:75] offset:0
  ds_write_b128 v3, v[76:79] offset:1280
  s_waitcnt lgkmcnt(0)
  s_barrier
  v_bfe_u32 v10, v7, 2, 2
  v_mul_u32_u24 v10, 2624, v10
  v_lshrrev_b32 v11, 5, v7
  v_mul_u32_u24 v12, 80, v11
  v_add_u32 v10, v10, v12
  v_and_b32 v12, 3, v7
  v_lshl_add_u32 v10, v12, 4, v10
  v_bfe_u32 v12, v7, 4, 1
  v_lshl_add_u32 v10, v12, 3, v10
  s_mul_i32 s47, s20, 320
  s_add_u32 s47, s47, 131072
  v_add_u32 v10, s47, v10
  ds_read_b64_tr_b16 v[32:33], v10 offset:0
  ds_read_b64_tr_b16 v[34:35], v10 offset:10496
  ds_read_b64_tr_b16 v[36:37], v10 offset:160
  ds_read_b64_tr_b16 v[38:39], v10 offset:10656
  v_lshlrev_b32 v11, 17, v11
  v_and_b32 v12, 31, v7
  v_lshl_add_u32 v11, v12, 4, v11
  s_lshl_b32 s47, s20, 19
  s_lshl_b32 s48, s2, 9
  s_add_u32 s47, s47, s48
  s_add_u32 s48, s47, 262144
  s_waitcnt lgkmcnt(2)
  buffer_store_dwordx4 v[32:35], v11, s[36:39], s47 offen sc1
  s_waitcnt lgkmcnt(0)
  buffer_store_dwordx4 v[36:39], v11, s[36:39], s48 offen sc1
  s_and_b32 s54, s2, 15
  s_waitcnt vmcnt(0)
  s_barrier
  s_cmp_lg_u32 s20, 0
  s_cbranch_scc1 x3_arr_skip
  s_lshl_b32 s10, s54, 8
  s_add_u32 s10, s10, 8192
  v_mov_b32 v228, s10
  v_mov_b32 v229, 1
  s_mov_b64 s[16:17], exec
  s_mov_b64 exec, 1
  buffer_atomic_add v229, v228, s[12:15], 0 offen sc1
  s_mov_b64 exec, s[16:17]
x3_arr_skip:
  s_mov_b32 s28, s70
  s_mov_b32 s29, s71
  s_mov_b32 s30, 14680064
  s_mov_b32 s31, 0x00020000
  s_cmp_lt_u32 s20, 4
  s_cbranch_scc1 p3_nodma
  s_cmp_eq_u32 s62, 0
  s_cbranch_scc1 p3_nodma
  s_add_u32 m0, s5, 0
  s_nop 0
  buffer_load_dwordx4 v224, s[28:31], s4 offen lds
  s_add_u32 m0, s5, 4096
  s_nop 0
  buffer_load_dwordx4 v225, s[28:31], s4 offen lds
  s_add_u32 m0, s5, 8192
  s_nop 0
  buffer_load_dwordx4 v226, s[28:31], s4 offen lds
  s_add_u32 m0, s5, 12288
  s_nop 0
  buffer_load_dwordx4 v227, s[28:31], s4 offen lds
  s_add_u32 s4, s4, s9
  s_add_u32 s5, s5, 16384
  s_cmp_ge_u32 s5, s7
  s_cselect_b32 s8, 131072, 0
  s_sub_u32 s5, s5, s8
  s_add_u32 m0, s5, 0
  s_nop 0
  buffer_load_dwordx4 v224, s[28:31], s4 offen lds
  s_add_u32 m0, s5, 4096
  s_nop 0
  buffer_load_dwordx4 v225, s[28:31], s4 offen lds
  s_add_u32 m0, s5, 8192
  s_nop 0
  buffer_load_dwordx4 v226, s[28:31], s4 offen lds
  s_add_u32 m0, s5, 12288
  s_nop 0
  buffer_load_dwordx4 v227, s[28:31], s4 offen lds
  s_add_u32 s4, s4, s9
  s_add_u32 s5, s5, 16384
  s_cmp_ge_u32 s5, s7
  s_cselect_b32 s8, 131072, 0
  s_sub_u32 s5, s5, s8
p3_nodma:
  s_cmp_eq_u32 s62, 0
  s_cbranch_scc1 g1_inactive
  s_add_u32 s24, s82, 12582912
  s_addc_u32 s25, s83, 0
  s_mov_b32 s26, 4194304
  s_mov_b32 s27, 0x00020000
  s_mov_b32 s28, s70
  s_mov_b32 s29, s71
  s_mov_b32 s30, 14680064
  s_mov_b32 s31, 0x00020000
  s_add_u32 s32, s82, 16777216
  s_addc_u32 s33, s83, 0
  s_mov_b32 s34, 7340032
  s_mov_b32 s35, 0x00020000
  s_mov_b32 s36, s72
  s_mov_b32 s37, s73
  s_mov_b32 s38, 7168
  s_mov_b32 s39, 0x00020000
  s_cmp_ge_u32 s20, 4
  s_cbranch_scc1 g1_loader
  v_and_b32 v8, 15, v7
  v_lshrrev_b32 v9, 4, v7
  v_lshrrev_b32 v10, 1, v9
  v_lshlrev_b32 v10, 10, v10
  v_and_b32 v11, 1, v9
  v_lshl_add_u32 v10, v11, 9, v10
  v_lshl_add_u32 v10, v8, 4, v10
  v_lshrrev_b32 v12, 2, v8
  v_lshl_add_u32 v13, v9, 3, v12
  v_lshlrev_b32 v12, 2, v12
  v_lshl_add_u32 v12, v11, 1, v12
  v_bfe_u32 v14, v7, 1, 1
  v_xor_b32 v12, v12, v14
  v_lshlrev_b32 v13, 8, v13
  v_lshl_add_u32 v13, v12, 4, v13
  v_and_b32 v14, 1, v7
  v_lshl_add_u32 v16, v14, 3, v13
  v_xor_b32 v17, 32, v16
  v_xor_b32 v18, 64, v16
  v_xor_b32 v19, 96, v16
  v_xor_b32 v20, 128, v16
  v_xor_b32 v21, 160, v16
  v_xor_b32 v22, 192, v16
  v_xor_b32 v23, 224, v16
  s_lshl_b32 s46, s61, 2
  s_add_u32 s46, s46, s20
  s_lshl_b32 s48, s46, 17
  v_add_u32 v1, s48, v10
  s_lshl_b32 s47, s60, 8
  v_lshlrev_b32 v11, 3, v9
  v_add_u32 v11, s47, v11
  buffer_load_dwordx2 v[192:193], v11, s[36:39], 0 offen offset:0
  buffer_load_dwordx2 v[194:195], v11, s[36:39], 0 offen offset:32
  buffer_load_dwordx2 v[196:197], v11, s[36:39], 0 offen offset:64
  buffer_load_dwordx2 v[198:199], v11, s[36:39], 0 offen offset:96
  buffer_load_dwordx2 v[200:201], v11, s[36:39], 0 offen offset:128
  buffer_load_dwordx2 v[202:203], v11, s[36:39], 0 offen offset:160
  buffer_load_dwordx2 v[204:205], v11, s[36:39], 0 offen offset:192
  buffer_load_dwordx2 v[206:207], v11, s[36:39], 0 offen offset:224
  s_mul_i32 s48, s46, 229376
  s_lshl_b32 s47, s60, 13
  s_add_u32 s47, s47, s48
  v_lshlrev_b32 v12, 4, v7
  v_add_u32 v28, s47, v12
  s_waitcnt vmcnt(0)
  v_lshlrev_b32 v32, 16, v192
  v_and_b32 v33, 0xffff0000, v192
  v_lshlrev_b32 v34, 16, v193
  v_and_b32 v35, 0xffff0000, v193
  v_lshlrev_b32 v36, 16, v192
  v_and_b32 v37, 0xffff0000, v192
  v_lshlrev_b32 v38, 16, v193
  v_and_b32 v39, 0xffff0000, v193
  v_lshlrev_b32 v40, 16, v194
  v_and_b32 v41, 0xffff0000, v194
  v_lshlrev_b32 v42, 16, v195
  v_and_b32 v43, 0xffff0000, v195
  v_lshlrev_b32 v44, 16, v194
  v_and_b32 v45, 0xffff0000, v194
  v_lshlrev_b32 v46, 16, v195
  v_and_b32 v47, 0xffff0000, v195
  v_lshlrev_b32 v48, 16, v196
  v_and_b32 v49, 0xffff0000, v196
  v_lshlrev_b32 v50, 16, v197
  v_and_b32 v51, 0xffff0000, v197
  v_lshlrev_b32 v52, 16, v196
  v_and_b32 v53, 0xffff0000, v196
  v_lshlrev_b32 v54, 16, v197
  v_and_b32 v55, 0xffff0000, v197
  v_lshlrev_b32 v56, 16, v198
  v_and_b32 v57, 0xffff0000, v198
  v_lshlrev_b32 v58, 16, v199
  v_and_b32 v59, 0xffff0000, v199
  v_lshlrev_b32 v60, 16, v198
  v_and_b32 v61, 0xffff0000, v198
  v_lshlrev_b32 v62, 16, v199
  v_and_b32 v63, 0xffff0000, v199
  v_lshlrev_b32 v64, 16, v200
  v_and_b32 v65, 0xffff0000, v200
  v_lshlrev_b32 v66, 16, v201
  v_and_b32 v67, 0xffff0000, v201
  v_lshlrev_b32 v68, 16, v200
  v_and_b32 v69, 0xffff0000, v200
  v_lshlrev_b32 v70, 16, v201
  v_and_b32 v71, 0xffff0000, v201
  v_lshlrev_b32 v72, 16, v202
  v_and_b32 v73, 0xffff0000, v202
  v_lshlrev_b32 v74, 16, v203
  v_and_b32 v75, 0xffff0000, v203
  v_lshlrev_b32 v76, 16, v202
  v_and_b32 v77, 0xffff0000, v202
  v_lshlrev_b32 v78, 16, v203
  v_and_b32 v79, 0xffff0000, v203
  v_lshlrev_b32 v80, 16, v204
  v_and_b32 v81, 0xffff0000, v204
  v_lshlrev_b32 v82, 16, v205
  v_and_b32 v83, 0xffff0000, v205
  v_lshlrev_b32 v84, 16, v204
  v_and_b32 v85, 0xffff0000, v204
  v_lshlrev_b32 v86, 16, v205
  v_and_b32 v87, 0xffff0000, v205
  v_lshlrev_b32 v88, 16, v206
  v_and_b32 v89, 0xffff0000, v206
  v_lshlrev_b32 v90, 16, v207
  v_and_b32 v91, 0xffff0000, v207
  v_lshlrev_b32 v92, 16, v206
  v_and_b32 v93, 0xffff0000, v206
  v_lshlrev_b32 v94, 16, v207
  v_and_b32 v95, 0xffff0000, v207
  v_mov_b32 v208, 0xc0135761
  v_mov_b32 v209, 0xc0135761
  v_mov_b32 v210, 0xbdd2d3e8
  v_mov_b32 v211, 0xbdd2d3e8
  s_mov_b32 s21, 0
  s_mov_b32 s23, 65536
  s_mov_b32 s22, 7
  s_cmp_lg_u32 s20, 0
  s_cbranch_scc1 x3c_w_skip
  v_and_b32 v228, 15, v7
  v_lshlrev_b32 v228, 8, v228
  v_add_u32 v228, 8192, v228
  s_mov_b32 s11, 200000
x3c_poll:
  buffer_load_dword v229, v228, s[12:15], 0 offen sc1
  s_waitcnt vmcnt(0)
  v_cmp_le_u32 vcc, 16, v229
  s_nop 1
  s_cmp_eq_u64 vcc, exec
  s_cbranch_scc1 x3c_w_skip
  s_sub_u32 s11, s11, 1
  s_cmp_lg_u32 s11, 0
  s_cbranch_scc1 x3c_poll
x3c_w_skip:
  s_barrier
  buffer_load_dwordx4 v[128:131], v1, s[24:27], s21 offen offset:0 sc1
  buffer_load_dwordx4 v[132:135], v1, s[24:27], s21 offen offset:256 sc1
  buffer_load_dwordx4 v[136:139], v1, s[24:27], s21 offen offset:2048 sc1
  buffer_load_dwordx4 v[140:143], v1, s[24:27], s21 offen offset:2304 sc1
  s_add_u32 s21, s21, 4096
  buffer_load_dwordx4 v[144:147], v1, s[24:27], s21 offen offset:0 sc1
  buffer_load_dwordx4 v[148:151], v1, s[24:27], s21 offen offset:256 sc1
  buffer_load_dwordx4 v[152:155], v1, s[24:27], s21 offen offset:2048 sc1
  buffer_load_dwordx4 v[156:159], v1, s[24:27], s21 offen offset:2304 sc1
  s_add_u32 s21, s21, 4096
  buffer_load_dwordx4 v[160:163], v1, s[24:27], s21 offen offset:0 sc1
  buffer_load_dwordx4 v[164:167], v1, s[24:27], s21 offen offset:256 sc1
  buffer_load_dwordx4 v[168:171], v1, s[24:27], s21 offen offset:2048 sc1
  buffer_load_dwordx4 v[172:175], v1, s[24:27], s21 offen offset:2304 sc1
  s_add_u32 s21, s21, 4096
  buffer_load_dwordx4 v[176:179], v1, s[24:27], s21 offen offset:0 sc1
  buffer_load_dwordx4 v[180:183], v1, s[24:27], s21 offen offset:256 sc1
  s_barrier
  ds_read_b64_tr_b16 v[96:97], v16 offset:0
  ds_read_b64_tr_b16 v[98:99], v16 offset:1024
  ds_read_b64_tr_b16 v[100:101], v17 offset:0
  ds_read_b64_tr_b16 v[102:103], v17 offset:1024
  ds_read_b64_tr_b16 v[104:105], v18 offset:0
  ds_read_b64_tr_b16 v[106:107], v18 offset:1024
  ds_read_b64_tr_b16 v[108:109], v19 offset:0
  ds_read_b64_tr_b16 v[110:111], v19 offset:1024
  ds_read_b64_tr_b16 v[112:113], v20 offset:0
  ds_read_b64_tr_b16 v[114:115], v20 offset:1024
  ds_read_b64_tr_b16 v[116:117], v21 offset:0
  ds_read_b64_tr_b16 v[118:119], v21 offset:1024
  ds_read_b64_tr_b16 v[120:121], v22 offset:0
  ds_read_b64_tr_b16 v[122:123], v22 offset:1024
g1_loop:
  s_waitcnt vmcnt(12)
  s_waitcnt lgkmcnt(10)
  v_mfma_f32_16x16x32_bf16 v[32:35], v[96:99], v[128:131], v[32:35]
  ds_read_b64_tr_b16 v[124:125], v23 offset:0
  buffer_load_dwordx4 v[184:187], v1, s[24:27], s21 offen offset:2048 sc1
  v_mfma_f32_16x16x32_bf16 v[36:39], v[96:99], v[132:135], v[36:39]
  ds_read_b64_tr_b16 v[126:127], v23 offset:1024
  v_mfma_f32_16x16x32_bf16 v[40:43], v[100:103], v[128:131], v[40:43]
  ds_read_b64_tr_b16 v[96:97], v16 offset:8192
  buffer_load_dwordx4 v[188:191], v1, s[24:27], s21 offen offset:2304 sc1
  v_mfma_f32_16x16x32_bf16 v[44:47], v[100:103], v[132:135], v[44:47]
  ds_read_b64_tr_b16 v[98:99], v16 offset:9216
  s_waitcnt lgkmcnt(10)
  v_mfma_f32_16x16x32_bf16 v[48:51], v[104:107], v[128:131], v[48:51]
  ds_read_b64_tr_b16 v[100:101], v17 offset:8192
  s_add_u32 s21, s21, 4096
  v_mfma_f32_16x16x32_bf16 v[52:55], v[104:107], v[132:135], v[52:55]
  ds_read_b64_tr_b16 v[102:103], v17 offset:9216
  v_mfma_f32_16x16x32_bf16 v[56:59], v[108:111], v[128:131], v[56:59]
  ds_read_b64_tr_b16 v[104:105], v18 offset:8192
  v_mfma_f32_16x16x32_bf16 v[60:63], v[108:111], v[132:135], v[60:63]
  ds_read_b64_tr_b16 v[106:107], v18 offset:9216
  s_waitcnt lgkmcnt(10)
  v_mfma_f32_16x16x32_bf16 v[64:67], v[112:115], v[128:131], v[64:67]
  ds_read_b64_tr_b16 v[108:109], v19 offset:8192
  v_mfma_f32_16x16x32_bf16 v[68:71], v[112:115], v[132:135], v[68:71]
  ds_read_b64_tr_b16 v[110:111], v19 offset:9216
  v_mfma_f32_16x16x32_bf16 v[72:75], v[116:119], v[128:131], v[72:75]
  ds_read_b64_tr_b16 v[112:113], v20 offset:8192
  v_mfma_f32_16x16x32_bf16 v[76:79], v[116:119], v[132:135], v[76:79]
  ds_read_b64_tr_b16 v[114:115], v20 offset:9216
  s_waitcnt lgkmcnt(10)
  v_mfma_f32_16x16x32_bf16 v[80:83], v[120:123], v[128:131], v[80:83]
  ds_read_b64_tr_b16 v[116:117], v21 offset:8192
  v_mfma_f32_16x16x32_bf16 v[84:87], v[120:123], v[132:135], v[84:87]
  ds_read_b64_tr_b16 v[118:119], v21 offset:9216
  v_mfma_f32_16x16x32_bf16 v[88:91], v[124:127], v[128:131], v[88:91]
  ds_read_b64_tr_b16 v[120:121], v22 offset:8192
  s_waitcnt vmcnt(12)
  v_mfma_f32_16x16x32_bf16 v[92:95], v[124:127], v[132:135], v[92:95]
  ds_read_b64_tr_b16 v[122:123], v22 offset:9216
  s_waitcnt lgkmcnt(10)
  v_mfma_f32_16x16x32_bf16 v[32:35], v[96:99], v[136:139], v[32:35]
  ds_read_b64_tr_b16 v[124:125], v23 offset:8192
  buffer_load_dwordx4 v[128:131], v1, s[24:27], s21 offen offset:0 sc1
  v_mfma_f32_16x16x32_bf16 v[36:39], v[96:99], v[140:143], v[36:39]
  ds_read_b64_tr_b16 v[126:127], v23 offset:9216
  s_barrier
  v_mfma_f32_16x16x32_bf16 v[40:43], v[100:103], v[136:139], v[40:43]
  ds_read_b64_tr_b16 v[96:97], v16 offset:16384
  buffer_load_dwordx4 v[132:135], v1, s[24:27], s21 offen offset:256 sc1
  v_mfma_f32_16x16x32_bf16 v[44:47], v[100:103], v[140:143], v[44:47]
  ds_read_b64_tr_b16 v[98:99], v16 offset:17408
  s_waitcnt lgkmcnt(10)
  v_mfma_f32_16x16x32_bf16 v[48:51], v[104:107], v[136:139], v[48:51]
  ds_read_b64_tr_b16 v[100:101], v17 offset:16384
  v_mfma_f32_16x16x32_bf16 v[52:55], v[104:107], v[140:143], v[52:55]
  ds_read_b64_tr_b16 v[102:103], v17 offset:17408
  v_mfma_f32_16x16x32_bf16 v[56:59], v[108:111], v[136:139], v[56:59]
  ds_read_b64_tr_b16 v[104:105], v18 offset:16384
  v_mfma_f32_16x16x32_bf16 v[60:63], v[108:111], v[140:143], v[60:63]
  ds_read_b64_tr_b16 v[106:107], v18 offset:17408
  s_waitcnt lgkmcnt(10)
  v_mfma_f32_16x16x32_bf16 v[64:67], v[112:115], v[136:139], v[64:67]
  ds_read_b64_tr_b16 v[108:109], v19 offset:16384
  v_mfma_f32_16x16x32_bf16 v[68:71], v[112:115], v[140:143], v[68:71]
  ds_read_b64_tr_b16 v[110:111], v19 offset:17408
  v_mfma_f32_16x16x32_bf16 v[72:75], v[116:119], v[136:139], v[72:75]
  ds_read_b64_tr_b16 v[112:113], v20 offset:16384
  v_mfma_f32_16x16x32_bf16 v[76:79], v[116:119], v[140:143], v[76:79]
  ds_read_b64_tr_b16 v[114:115], v20 offset:17408
  s_waitcnt lgkmcnt(10)
  v_mfma_f32_16x16x32_bf16 v[80:83], v[120:123], v[136:139], v[80:83]
  ds_read_b64_tr_b16 v[116:117], v21 offset:16384
  v_mfma_f32_16x16x32_bf16 v[84:87], v[120:123], v[140:143], v[84:87]
  ds_read_b64_tr_b16 v[118:119], v21 offset:17408
  v_mfma_f32_16x16x32_bf16 v[88:91], v[124:127], v[136:139], v[88:91]
  ds_read_b64_tr_b16 v[120:121], v22 offset:16384
  s_waitcnt vmcnt(12)
  v_mfma_f32_16x16x32_bf16 v[92:95], v[124:127], v[140:143], v[92:95]
  ds_read_b64_tr_b16 v[122:123], v22 offset:17408
  s_waitcnt lgkmcnt(10)
  v_mfma_f32_16x16x32_bf16 v[32:35], v[96:99], v[144:147], v[32:35]
  ds_read_b64_tr_b16 v[124:125], v23 offset:16384
  buffer_load_dwordx4 v[136:139], v1, s[24:27], s21 offen offset:2048 sc1
  v_mfma_f32_16x16x32_bf16 v[36:39], v[96:99], v[148:151], v[36:39]
  ds_read_b64_tr_b16 v[126:127], v23 offset:17408
  v_mfma_f32_16x16x32_bf16 v[40:43], v[100:103], v[144:147], v[40:43]
  ds_read_b64_tr_b16 v[96:97], v16 offset:24576
  buffer_load_dwordx4 v[140:143], v1, s[24:27], s21 offen offset:2304 sc1
  v_mfma_f32_16x16x32_bf16 v[44:47], v[100:103], v[148:151], v[44:47]
  ds_read_b64_tr_b16 v[98:99], v16 offset:25600
  s_waitcnt lgkmcnt(10)
  v_mfma_f32_16x16x32_bf16 v[48:51], v[104:107], v[144:147], v[48:51]
  ds_read_b64_tr_b16 v[100:101], v17 offset:24576
  s_add_u32 s21, s21, 4096
  v_mfma_f32_16x16x32_bf16 v[52:55], v[104:107], v[148:151], v[52:55]
  ds_read_b64_tr_b16 v[102:103], v17 offset:25600
  v_mfma_f32_16x16x32_bf16 v[56:59], v[108:111], v[144:147], v[56:59]
  ds_read_b64_tr_b16 v[104:105], v18 offset:24576
  v_mfma_f32_16x16x32_bf16 v[60:63], v[108:111], v[148:151], v[60:63]
  ds_read_b64_tr_b16 v[106:107], v18 offset:25600
  s_waitcnt lgkmcnt(10)
  v_mfma_f32_16x16x32_bf16 v[64:67], v[112:115], v[144:147], v[64:67]
  ds_read_b64_tr_b16 v[108:109], v19 offset:24576
  v_mfma_f32_16x16x32_bf16 v[68:71], v[112:115], v[148:151], v[68:71]
  ds_read_b64_tr_b16 v[110:111], v19 offset:25600
  v_mfma_f32_16x16x32_bf16 v[72:75], v[116:119], v[144:147], v[72:75]
  ds_read_b64_tr_b16 v[112:113], v20 offset:24576
  v_mfma_f32_16x16x32_bf16 v[76:79], v[116:119], v[148:151], v[76:79]
  ds_read_b64_tr_b16 v[114:115], v20 offset:25600
  s_waitcnt lgkmcnt(10)
  v_mfma_f32_16x16x32_bf16 v[80:83], v[120:123], v[144:147], v[80:83]
  ds_read_b64_tr_b16 v[116:117], v21 offset:24576
  v_mfma_f32_16x16x32_bf16 v[84:87], v[120:123], v[148:151], v[84:87]
  ds_read_b64_tr_b16 v[118:119], v21 offset:25600
  v_mfma_f32_16x16x32_bf16 v[88:91], v[124:127], v[144:147], v[88:91]
  ds_read_b64_tr_b16 v[120:121], v22 offset:24576
  s_waitcnt vmcnt(12)
  v_mfma_f32_16x16x32_bf16 v[92:95], v[124:127], v[148:151], v[92:95]
  ds_read_b64_tr_b16 v[122:123], v22 offset:25600
  s_waitcnt lgkmcnt(10)
  v_mfma_f32_16x16x32_bf16 v[32:35], v[96:99], v[152:155], v[32:35]
  ds_read_b64_tr_b16 v[124:125], v23 offset:24576
  buffer_load_dwordx4 v[144:147], v1, s[24:27], s21 offen offset:0 sc1
  v_mfma_f32_16x16x32_bf16 v[36:39], v[96:99], v[156:159], v[36:39]
  ds_read_b64_tr_b16 v[126:127], v23 offset:25600
  s_barrier
  v_mfma_f32_16x16x32_bf16 v[40:43], v[100:103], v[152:155], v[40:43]
  ds_read_b64_tr_b16 v[96:97], v16 offset:32768
  buffer_load_dwordx4 v[148:151], v1, s[24:27], s21 offen offset:256 sc1
  v_mfma_f32_16x16x32_bf16 v[44:47], v[100:103], v[156:159], v[44:47]
  ds_read_b64_tr_b16 v[98:99], v16 offset:33792
  s_waitcnt lgkmcnt(10)
  v_mfma_f32_16x16x32_bf16 v[48:51], v[104:107], v[152:155], v[48:51]
  ds_read_b64_tr_b16 v[100:101], v17 offset:32768
  v_mfma_f32_16x16x32_bf16 v[52:55], v[104:107], v[156:159], v[52:55]
  ds_read_b64_tr_b16 v[102:103], v17 offset:33792
  v_mfma_f32_16x16x32_bf16 v[56:59], v[108:111], v[152:155], v[56:59]
  ds_read_b64_tr_b16 v[104:105], v18 offset:32768
  v_mfma_f32_16x16x32_bf16 v[60:63], v[108:111], v[156:159], v[60:63]
  ds_read_b64_tr_b16 v[106:107], v18 offset:33792
  s_waitcnt lgkmcnt(10)
  v_mfma_f32_16x16x32_bf16 v[64:67], v[112:115], v[152:155], v[64:67]
  ds_read_b64_tr_b16 v[108:109], v19 offset:32768
  v_mfma_f32_16x16x32_bf16 v[68:71], v[112:115], v[156:159], v[68:71]
  ds_read_b64_tr_b16 v[110:111], v19 offset:33792
  v_mfma_f32_16x16x32_bf16 v[72:75], v[116:119], v[152:155], v[72:75]
  ds_read_b64_tr_b16 v[112:113], v20 offset:32768
  v_mfma_f32_16x16x32_bf16 v[76:79], v[116:119], v[156:159], v[76:79]
  ds_read_b64_tr_b16 v[114:115], v20 offset:33792
  s_waitcnt lgkmcnt(10)
  v_mfma_f32_16x16x32_bf16 v[80:83], v[120:123], v[152:155], v[80:83]
  ds_read_b64_tr_b16 v[116:117], v21 offset:32768
  v_mfma_f32_16x16x32_bf16 v[84:87], v[120:123], v[156:159], v[84:87]
  ds_read_b64_tr_b16 v[118:119], v21 offset:33792
  v_mfma_f32_16x16x32_bf16 v[88:91], v[124:127], v[152:155], v[88:91]
  ds_read_b64_tr_b16 v[120:121], v22 offset:32768
  s_waitcnt vmcnt(12)
  v_mfma_f32_16x16x32_bf16 v[92:95], v[124:127], v[156:159], v[92:95]
  ds_read_b64_tr_b16 v[122:123], v22 offset:33792
  s_waitcnt lgkmcnt(10)
  v_mfma_f32_16x16x32_bf16 v[32:35], v[96:99], v[160:163], v[32:35]
  ds_read_b64_tr_b16 v[124:125], v23 offset:32768
  buffer_load_dwordx4 v[152:155], v1, s[24:27], s21 offen offset:2048 sc1
  v_mfma_f32_16x16x32_bf16 v[36:39], v[96:99], v[164:167], v[36:39]
  ds_read_b64_tr_b16 v[126:127], v23 offset:33792
  v_mfma_f32_16x16x32_bf16 v[40:43], v[100:103], v[160:163], v[40:43]
  ds_read_b64_tr_b16 v[96:97], v16 offset:40960
  buffer_load_dwordx4 v[156:159], v1, s[24:27], s21 offen offset:2304 sc1
  v_mfma_f32_16x16x32_bf16 v[44:47], v[100:103], v[164:167], v[44:47]
  ds_read_b64_tr_b16 v[98:99], v16 offset:41984
  s_waitcnt lgkmcnt(10)
  v_mfma_f32_16x16x32_bf16 v[48:51], v[104:107], v[160:163], v[48:51]
  ds_read_b64_tr_b16 v[100:101], v17 offset:40960
  s_add_u32 s21, s21, 4096
  v_mfma_f32_16x16x32_bf16 v[52:55], v[104:107], v[164:167], v[52:55]
  ds_read_b64_tr_b16 v[102:103], v17 offset:41984
  v_mfma_f32_16x16x32_bf16 v[56:59], v[108:111], v[160:163], v[56:59]
  ds_read_b64_tr_b16 v[104:105], v18 offset:40960
  v_mfma_f32_16x16x32_bf16 v[60:63], v[108:111], v[164:167], v[60:63]
  ds_read_b64_tr_b16 v[106:107], v18 offset:41984
  s_waitcnt lgkmcnt(10)
  v_mfma_f32_16x16x32_bf16 v[64:67], v[112:115], v[160:163], v[64:67]
  ds_read_b64_tr_b16 v[108:109], v19 offset:40960
  v_mfma_f32_16x16x32_bf16 v[68:71], v[112:115], v[164:167], v[68:71]
  ds_read_b64_tr_b16 v[110:111], v19 offset:41984
  v_mfma_f32_16x16x32_bf16 v[72:75], v[116:119], v[160:163], v[72:75]
  ds_read_b64_tr_b16 v[112:113], v20 offset:40960
  v_mfma_f32_16x16x32_bf16 v[76:79], v[116:119], v[164:167], v[76:79]
  ds_read_b64_tr_b16 v[114:115], v20 offset:41984
  s_waitcnt lgkmcnt(10)
  v_mfma_f32_16x16x32_bf16 v[80:83], v[120:123], v[160:163], v[80:83]
  ds_read_b64_tr_b16 v[116:117], v21 offset:40960
  v_mfma_f32_16x16x32_bf16 v[84:87], v[120:123], v[164:167], v[84:87]
  ds_read_b64_tr_b16 v[118:119], v21 offset:41984
  v_mfma_f32_16x16x32_bf16 v[88:91], v[124:127], v[160:163], v[88:91]
  ds_read_b64_tr_b16 v[120:121], v22 offset:40960
  s_waitcnt vmcnt(12)
  v_mfma_f32_16x16x32_bf16 v[92:95], v[124:127], v[164:167], v[92:95]
  ds_read_b64_tr_b16 v[122:123], v22 offset:41984
  s_waitcnt lgkmcnt(10)
  v_mfma_f32_16x16x32_bf16 v[32:35], v[96:99], v[168:171], v[32:35]
  ds_read_b64_tr_b16 v[124:125], v23 offset:40960
  buffer_load_dwordx4 v[160:163], v1, s[24:27], s21 offen offset:0 sc1
  v_mfma_f32_16x16x32_bf16 v[36:39], v[96:99], v[172:175], v[36:39]
  ds_read_b64_tr_b16 v[126:127], v23 offset:41984
  s_barrier
  v_mfma_f32_16x16x32_bf16 v[40:43], v[100:103], v[168:171], v[40:43]
  ds_read_b64_tr_b16 v[96:97], v16 offset:49152
  buffer_load_dwordx4 v[164:167], v1, s[24:27], s21 offen offset:256 sc1
  v_mfma_f32_16x16x32_bf16 v[44:47], v[100:103], v[172:175], v[44:47]
  ds_read_b64_tr_b16 v[98:99], v16 offset:50176
  s_waitcnt lgkmcnt(10)
  v_mfma_f32_16x16x32_bf16 v[48:51], v[104:107], v[168:171], v[48:51]
  ds_read_b64_tr_b16 v[100:101], v17 offset:49152
  v_mfma_f32_16x16x32_bf16 v[52:55], v[104:107], v[172:175], v[52:55]
  ds_read_b64_tr_b16 v[102:103], v17 offset:50176
  v_mfma_f32_16x16x32_bf16 v[56:59], v[108:111], v[168:171], v[56:59]
  ds_read_b64_tr_b16 v[104:105], v18 offset:49152
  v_mfma_f32_16x16x32_bf16 v[60:63], v[108:111], v[172:175], v[60:63]
  ds_read_b64_tr_b16 v[106:107], v18 offset:50176
  s_waitcnt lgkmcnt(10)
  v_mfma_f32_16x16x32_bf16 v[64:67], v[112:115], v[168:171], v[64:67]
  ds_read_b64_tr_b16 v[108:109], v19 offset:49152
  v_mfma_f32_16x16x32_bf16 v[68:71], v[112:115], v[172:175], v[68:71]
  ds_read_b64_tr_b16 v[110:111], v19 offset:50176
  v_mfma_f32_16x16x32_bf16 v[72:75], v[116:119], v[168:171], v[72:75]
  ds_read_b64_tr_b16 v[112:113], v20 offset:49152
  v_mfma_f32_16x16x32_bf16 v[76:79], v[116:119], v[172:175], v[76:79]
  ds_read_b64_tr_b16 v[114:115], v20 offset:50176
  s_waitcnt lgkmcnt(10)
  v_mfma_f32_16x16x32_bf16 v[80:83], v[120:123], v[168:171], v[80:83]
  ds_read_b64_tr_b16 v[116:117], v21 offset:49152
  v_mfma_f32_16x16x32_bf16 v[84:87], v[120:123], v[172:175], v[84:87]
  ds_read_b64_tr_b16 v[118:119], v21 offset:50176
  v_mfma_f32_16x16x32_bf16 v[88:91], v[124:127], v[168:171], v[88:91]
  ds_read_b64_tr_b16 v[120:121], v22 offset:49152
  s_waitcnt vmcnt(12)
  v_mfma_f32_16x16x32_bf16 v[92:95], v[124:127], v[172:175], v[92:95]
  ds_read_b64_tr_b16 v[122:123], v22 offset:50176
  s_waitcnt lgkmcnt(10)
  v_mfma_f32_16x16x32_bf16 v[32:35], v[96:99], v[176:179], v[32:35]
  ds_read_b64_tr_b16 v[124:125], v23 offset:49152
  buffer_load_dwordx4 v[168:171], v1, s[24:27], s21 offen offset:2048 sc1
  v_mfma_f32_16x16x32_bf16 v[36:39], v[96:99], v[180:183], v[36:39]
  ds_read_b64_tr_b16 v[126:127], v23 offset:50176
  v_mfma_f32_16x16x32_bf16 v[40:43], v[100:103], v[176:179], v[40:43]
  ds_read_b64_tr_b16 v[96:97], v16 offset:57344
  buffer_load_dwordx4 v[172:175], v1, s[24:27], s21 offen offset:2304 sc1
  v_mfma_f32_16x16x32_bf16 v[44:47], v[100:103], v[180:183], v[44:47]
  ds_read_b64_tr_b16 v[98:99], v16 offset:58368
  s_waitcnt lgkmcnt(10)
  v_mfma_f32_16x16x32_bf16 v[48:51], v[104:107], v[176:179], v[48:51]
  ds_read_b64_tr_b16 v[100:101], v17 offset:57344
  s_add_u32 s21, s21, 4096
  v_mfma_f32_16x16x32_bf16 v[52:55], v[104:107], v[180:183], v[52:55]
  ds_read_b64_tr_b16 v[102:103], v17 offset:58368
  v_mfma_f32_16x16x32_bf16 v[56:59], v[108:111], v[176:179], v[56:59]
  ds_read_b64_tr_b16 v[104:105], v18 offset:57344
  v_mfma_f32_16x16x32_bf16 v[60:63], v[108:111], v[180:183], v[60:63]
  ds_read_b64_tr_b16 v[106:107], v18 offset:58368
  s_waitcnt lgkmcnt(10)
  v_mfma_f32_16x16x32_bf16 v[64:67], v[112:115], v[176:179], v[64:67]
  ds_read_b64_tr_b16 v[108:109], v19 offset:57344
  v_mfma_f32_16x16x32_bf16 v[68:71], v[112:115], v[180:183], v[68:71]
  ds_read_b64_tr_b16 v[110:111], v19 offset:58368
  v_mfma_f32_16x16x32_bf16 v[72:75], v[116:119], v[176:179], v[72:75]
  ds_read_b64_tr_b16 v[112:113], v20 offset:57344
  v_mfma_f32_16x16x32_bf16 v[76:79], v[116:119], v[180:183], v[76:79]
  ds_read_b64_tr_b16 v[114:115], v20 offset:58368
  s_waitcnt lgkmcnt(10)
  v_mfma_f32_16x16x32_bf16 v[80:83], v[120:123], v[176:179], v[80:83]
  ds_read_b64_tr_b16 v[116:117], v21 offset:57344
  v_mfma_f32_16x16x32_bf16 v[84:87], v[120:123], v[180:183], v[84:87]
  ds_read_b64_tr_b16 v[118:119], v21 offset:58368
  v_mfma_f32_16x16x32_bf16 v[88:91], v[124:127], v[176:179], v[88:91]
  ds_read_b64_tr_b16 v[120:121], v22 offset:57344
  s_waitcnt vmcnt(12)
  v_mfma_f32_16x16x32_bf16 v[92:95], v[124:127], v[180:183], v[92:95]
  ds_read_b64_tr_b16 v[122:123], v22 offset:58368
  s_waitcnt lgkmcnt(10)
  v_mfma_f32_16x16x32_bf16 v[32:35], v[96:99], v[184:187], v[32:35]
  ds_read_b64_tr_b16 v[124:125], v23 offset:57344
  buffer_load_dwordx4 v[176:179], v1, s[24:27], s21 offen offset:0 sc1
  v_mfma_f32_16x16x32_bf16 v[36:39], v[96:99], v[188:191], v[36:39]
  ds_read_b64_tr_b16 v[126:127], v23 offset:58368
  s_barrier
  v_add_u32 v16, s23, v16
  v_mfma_f32_16x16x32_bf16 v[40:43], v[100:103], v[184:187], v[40:43]
  ds_read_b64_tr_b16 v[96:97], v16 offset:0
  buffer_load_dwordx4 v[180:183], v1, s[24:27], s21 offen offset:256 sc1
  v_mfma_f32_16x16x32_bf16 v[44:47], v[100:103], v[188:191], v[44:47]
  ds_read_b64_tr_b16 v[98:99], v16 offset:1024
  s_waitcnt lgkmcnt(10)
  v_add_u32 v17, s23, v17
  v_mfma_f32_16x16x32_bf16 v[48:51], v[104:107], v[184:187], v[48:51]
  ds_read_b64_tr_b16 v[100:101], v17 offset:0
  v_mfma_f32_16x16x32_bf16 v[52:55], v[104:107], v[188:191], v[52:55]
  ds_read_b64_tr_b16 v[102:103], v17 offset:1024
  v_add_u32 v18, s23, v18
  v_mfma_f32_16x16x32_bf16 v[56:59], v[108:111], v[184:187], v[56:59]
  ds_read_b64_tr_b16 v[104:105], v18 offset:0
  v_mfma_f32_16x16x32_bf16 v[60:63], v[108:111], v[188:191], v[60:63]
  ds_read_b64_tr_b16 v[106:107], v18 offset:1024
  s_waitcnt lgkmcnt(10)
  v_add_u32 v19, s23, v19
  v_mfma_f32_16x16x32_bf16 v[64:67], v[112:115], v[184:187], v[64:67]
  ds_read_b64_tr_b16 v[108:109], v19 offset:0
  v_mfma_f32_16x16x32_bf16 v[68:71], v[112:115], v[188:191], v[68:71]
  ds_read_b64_tr_b16 v[110:111], v19 offset:1024
  v_add_u32 v20, s23, v20
  v_mfma_f32_16x16x32_bf16 v[72:75], v[116:119], v[184:187], v[72:75]
  ds_read_b64_tr_b16 v[112:113], v20 offset:0
  v_mfma_f32_16x16x32_bf16 v[76:79], v[116:119], v[188:191], v[76:79]
  ds_read_b64_tr_b16 v[114:115], v20 offset:1024
  s_waitcnt lgkmcnt(10)
  v_add_u32 v21, s23, v21
  v_mfma_f32_16x16x32_bf16 v[80:83], v[120:123], v[184:187], v[80:83]
  ds_read_b64_tr_b16 v[116:117], v21 offset:0
  v_mfma_f32_16x16x32_bf16 v[84:87], v[120:123], v[188:191], v[84:87]
  ds_read_b64_tr_b16 v[118:119], v21 offset:1024
  v_add_u32 v22, s23, v22
  v_mfma_f32_16x16x32_bf16 v[88:91], v[124:127], v[184:187], v[88:91]
  ds_read_b64_tr_b16 v[120:121], v22 offset:0
  v_mfma_f32_16x16x32_bf16 v[92:95], v[124:127], v[188:191], v[92:95]
  ds_read_b64_tr_b16 v[122:123], v22 offset:1024
  v_add_u32 v23, s23, v23
  s_sub_u32 s23, 0, s23
  s_sub_u32 s22, s22, 1
  s_cmp_lg_u32 s22, 0
  s_cbranch_scc1 g1_loop
  s_waitcnt vmcnt(12)
  s_waitcnt lgkmcnt(10)
  v_mfma_f32_16x16x32_bf16 v[32:35], v[96:99], v[128:131], v[32:35]
  ds_read_b64_tr_b16 v[124:125], v23 offset:0
  v_mfma_f32_16x16x32_bf16 v[36:39], v[96:99], v[132:135], v[36:39]
  ds_read_b64_tr_b16 v[126:127], v23 offset:1024
  buffer_load_dwordx4 v[184:187], v1, s[24:27], s21 offen offset:2048 sc1
  buffer_load_dwordx4 v[188:191], v1, s[24:27], s21 offen offset:2304 sc1
  s_add_u32 s21, s21, 4096
  v_mfma_f32_16x16x32_bf16 v[40:43], v[100:103], v[128:131], v[40:43]
  ds_read_b64_tr_b16 v[96:97], v16 offset:8192
  v_mfma_f32_16x16x32_bf16 v[44:47], v[100:103], v[132:135], v[44:47]
  ds_read_b64_tr_b16 v[98:99], v16 offset:9216
  s_waitcnt lgkmcnt(10)
  v_mfma_f32_16x16x32_bf16 v[48:51], v[104:107], v[128:131], v[48:51]
  ds_read_b64_tr_b16 v[100:101], v17 offset:8192
  v_mfma_f32_16x16x32_bf16 v[52:55], v[104:107], v[132:135], v[52:55]
  ds_read_b64_tr_b16 v[102:103], v17 offset:9216
  v_mfma_f32_16x16x32_bf16 v[56:59], v[108:111], v[128:131], v[56:59]
  ds_read_b64_tr_b16 v[104:105], v18 offset:8192
  v_mfma_f32_16x16x32_bf16 v[60:63], v[108:111], v[132:135], v[60:63]
  ds_read_b64_tr_b16 v[106:107], v18 offset:9216
  s_waitcnt lgkmcnt(10)
  v_mfma_f32_16x16x32_bf16 v[64:67], v[112:115], v[128:131], v[64:67]
  ds_read_b64_tr_b16 v[108:109], v19 offset:8192
  v_mfma_f32_16x16x32_bf16 v[68:71], v[112:115], v[132:135], v[68:71]
  ds_read_b64_tr_b16 v[110:111], v19 offset:9216
  v_mfma_f32_16x16x32_bf16 v[72:75], v[116:119], v[128:131], v[72:75]
  ds_read_b64_tr_b16 v[112:113], v20 offset:8192
  v_mfma_f32_16x16x32_bf16 v[76:79], v[116:119], v[132:135], v[76:79]
  ds_read_b64_tr_b16 v[114:115], v20 offset:9216
  s_waitcnt lgkmcnt(10)
  v_mfma_f32_16x16x32_bf16 v[80:83], v[120:123], v[128:131], v[80:83]
  ds_read_b64_tr_b16 v[116:117], v21 offset:8192
  v_mfma_f32_16x16x32_bf16 v[84:87], v[120:123], v[132:135], v[84:87]
  ds_read_b64_tr_b16 v[118:119], v21 offset:9216
  v_mfma_f32_16x16x32_bf16 v[88:91], v[124:127], v[128:131], v[88:91]
  ds_read_b64_tr_b16 v[120:121], v22 offset:8192
  v_mfma_f32_16x16x32_bf16 v[92:95], v[124:127], v[132:135], v[92:95]
  ds_read_b64_tr_b16 v[122:123], v22 offset:9216
  s_waitcnt vmcnt(12)
  s_waitcnt lgkmcnt(10)
  v_mfma_f32_16x16x32_bf16 v[32:35], v[96:99], v[136:139], v[32:35]
  ds_read_b64_tr_b16 v[124:125], v23 offset:8192
  v_mfma_f32_16x16x32_bf16 v[36:39], v[96:99], v[140:143], v[36:39]
  ds_read_b64_tr_b16 v[126:127], v23 offset:9216
  s_barrier
  s_barrier
  v_mfma_f32_16x16x32_bf16 v[40:43], v[100:103], v[136:139], v[40:43]
  ds_read_b64_tr_b16 v[96:97], v16 offset:16384
  v_mfma_f32_16x16x32_bf16 v[44:47], v[100:103], v[140:143], v[44:47]
  ds_read_b64_tr_b16 v[98:99], v16 offset:17408
  s_waitcnt lgkmcnt(10)
  v_mfma_f32_16x16x32_bf16 v[48:51], v[104:107], v[136:139], v[48:51]
  ds_read_b64_tr_b16 v[100:101], v16 offset:24576
  v_mfma_f32_16x16x32_bf16 v[52:55], v[104:107], v[140:143], v[52:55]
  ds_read_b64_tr_b16 v[102:103], v16 offset:25600
  v_mfma_f32_16x16x32_bf16 v[56:59], v[108:111], v[136:139], v[56:59]
  ds_read_b64_tr_b16 v[104:105], v16 offset:32768
  v_mfma_f32_16x16x32_bf16 v[60:63], v[108:111], v[140:143], v[60:63]
  ds_read_b64_tr_b16 v[106:107], v16 offset:33792
  s_waitcnt lgkmcnt(10)
  v_mfma_f32_16x16x32_bf16 v[64:67], v[112:115], v[136:139], v[64:67]
  ds_read_b64_tr_b16 v[108:109], v16 offset:40960
  v_mfma_f32_16x16x32_bf16 v[68:71], v[112:115], v[140:143], v[68:71]
  ds_read_b64_tr_b16 v[110:111], v16 offset:41984
  s_barrier
  v_mfma_f32_16x16x32_bf16 v[72:75], v[116:119], v[136:139], v[72:75]
  ds_read_b64_tr_b16 v[112:113], v16 offset:49152
  v_mfma_f32_16x16x32_bf16 v[76:79], v[116:119], v[140:143], v[76:79]
  ds_read_b64_tr_b16 v[114:115], v16 offset:50176
  s_waitcnt lgkmcnt(10)
  v_mfma_f32_16x16x32_bf16 v[80:83], v[120:123], v[136:139], v[80:83]
  ds_read_b64_tr_b16 v[116:117], v16 offset:57344
  v_mfma_f32_16x16x32_bf16 v[84:87], v[120:123], v[140:143], v[84:87]
  ds_read_b64_tr_b16 v[118:119], v16 offset:58368
  v_mfma_f32_16x16x32_bf16 v[88:91], v[124:127], v[136:139], v[88:91]
  ds_read_b64_tr_b16 v[120:121], v17 offset:16384
  v_mfma_f32_16x16x32_bf16 v[92:95], v[124:127], v[140:143], v[92:95]
  ds_read_b64_tr_b16 v[122:123], v17 offset:17408
  s_waitcnt vmcnt(10)
  s_waitcnt lgkmcnt(10)
  v_mfma_f32_16x16x32_bf16 v[32:35], v[96:99], v[144:147], v[32:35]
  ds_read_b64_tr_b16 v[124:125], v17 offset:24576
  v_mfma_f32_16x16x32_bf16 v[36:39], v[96:99], v[148:151], v[36:39]
  ds_read_b64_tr_b16 v[126:127], v17 offset:25600
  s_waitcnt vmcnt(8)
  v_mfma_f32_16x16x32_bf16 v[32:35], v[100:103], v[152:155], v[32:35]
  ds_read_b64_tr_b16 v[96:97], v17 offset:32768
  v_mfma_f32_16x16x32_bf16 v[36:39], v[100:103], v[156:159], v[36:39]
  ds_read_b64_tr_b16 v[98:99], v17 offset:33792
  s_waitcnt vmcnt(6)
  s_waitcnt lgkmcnt(10)
  v_mfma_f32_16x16x32_bf16 v[32:35], v[104:107], v[160:163], v[32:35]
  ds_read_b64_tr_b16 v[100:101], v17 offset:40960
  v_mfma_f32_16x16x32_bf16 v[36:39], v[104:107], v[164:167], v[36:39]
  ds_read_b64_tr_b16 v[102:103], v17 offset:41984
  s_waitcnt vmcnt(4)
  v_mfma_f32_16x16x32_bf16 v[32:35], v[108:111], v[168:171], v[32:35]
  ds_read_b64_tr_b16 v[104:105], v17 offset:49152
  v_mfma_f32_16x16x32_bf16 v[36:39], v[108:111], v[172:175], v[36:39]
  ds_read_b64_tr_b16 v[106:107], v17 offset:50176
  s_waitcnt vmcnt(2)
  s_waitcnt lgkmcnt(10)
  v_mfma_f32_16x16x32_bf16 v[32:35], v[112:115], v[176:179], v[32:35]
  ds_read_b64_tr_b16 v[108:109], v17 offset:57344
  v_mfma_f32_16x16x32_bf16 v[36:39], v[112:115], v[180:183], v[36:39]
  ds_read_b64_tr_b16 v[110:111], v17 offset:58368
  s_waitcnt vmcnt(0)
  v_mfma_f32_16x16x32_bf16 v[32:35], v[116:119], v[184:187], v[32:35]
  ds_read_b64_tr_b16 v[112:113], v18 offset:16384
  v_mfma_f32_16x16x32_bf16 v[36:39], v[116:119], v[188:191], v[36:39]
  ds_read_b64_tr_b16 v[114:115], v18 offset:17408
  s_waitcnt lgkmcnt(10)
  v_mfma_f32_16x16x32_bf16 v[40:43], v[120:123], v[144:147], v[40:43]
  ds_read_b64_tr_b16 v[116:117], v18 offset:24576
  v_mfma_f32_16x16x32_bf16 v[44:47], v[120:123], v[148:151], v[44:47]
  ds_read_b64_tr_b16 v[118:119], v18 offset:25600
  v_mfma_f32_16x16x32_bf16 v[40:43], v[124:127], v[152:155], v[40:43]
  ds_read_b64_tr_b16 v[120:121], v18 offset:32768
  v_mfma_f32_16x16x32_bf16 v[44:47], v[124:127], v[156:159], v[44:47]
  ds_read_b64_tr_b16 v[122:123], v18 offset:33792
  s_waitcnt lgkmcnt(10)
  v_mfma_f32_16x16x32_bf16 v[40:43], v[96:99], v[160:163], v[40:43]
  ds_read_b64_tr_b16 v[124:125], v18 offset:40960
  v_mfma_f32_16x16x32_bf16 v[44:47], v[96:99], v[164:167], v[44:47]
  ds_read_b64_tr_b16 v[126:127], v18 offset:41984
  v_mfma_f32_16x16x32_bf16 v[40:43], v[100:103], v[168:171], v[40:43]
  ds_read_b64_tr_b16 v[96:97], v18 offset:49152
  v_mfma_f32_16x16x32_bf16 v[44:47], v[100:103], v[172:175], v[44:47]
  ds_read_b64_tr_b16 v[98:99], v18 offset:50176
  s_waitcnt lgkmcnt(10)
  v_mfma_f32_16x16x32_bf16 v[40:43], v[104:107], v[176:179], v[40:43]
  ds_read_b64_tr_b16 v[100:101], v18 offset:57344
  v_mfma_f32_16x16x32_bf16 v[44:47], v[104:107], v[180:183], v[44:47]
  ds_read_b64_tr_b16 v[102:103], v18 offset:58368
  v_mfma_f32_16x16x32_bf16 v[40:43], v[108:111], v[184:187], v[40:43]
  ds_read_b64_tr_b16 v[104:105], v19 offset:16384
  v_mfma_f32_16x16x32_bf16 v[44:47], v[108:111], v[188:191], v[44:47]
  ds_read_b64_tr_b16 v[106:107], v19 offset:17408
  s_waitcnt lgkmcnt(10)
  v_mfma_f32_16x16x32_bf16 v[48:51], v[112:115], v[144:147], v[48:51]
  ds_read_b64_tr_b16 v[108:109], v19 offset:24576
  v_mfma_f32_16x16x32_bf16 v[52:55], v[112:115], v[148:151], v[52:55]
  ds_read_b64_tr_b16 v[110:111], v19 offset:25600
  v_mfma_f32_16x16x32_bf16 v[48:51], v[116:119], v[152:155], v[48:51]
  ds_read_b64_tr_b16 v[112:113], v19 offset:32768
  v_mfma_f32_16x16x32_bf16 v[52:55], v[116:119], v[156:159], v[52:55]
  ds_read_b64_tr_b16 v[114:115], v19 offset:33792
  s_waitcnt lgkmcnt(10)
  v_mfma_f32_16x16x32_bf16 v[48:51], v[120:123], v[160:163], v[48:51]
  ds_read_b64_tr_b16 v[116:117], v19 offset:40960
  v_mfma_f32_16x16x32_bf16 v[52:55], v[120:123], v[164:167], v[52:55]
  ds_read_b64_tr_b16 v[118:119], v19 offset:41984
  v_mfma_f32_16x16x32_bf16 v[48:51], v[124:127], v[168:171], v[48:51]
  ds_read_b64_tr_b16 v[120:121], v19 offset:49152
  v_mfma_f32_16x16x32_bf16 v[52:55], v[124:127], v[172:175], v[52:55]
  ds_read_b64_tr_b16 v[122:123], v19 offset:50176
  s_waitcnt lgkmcnt(10)
  v_mfma_f32_16x16x32_bf16 v[48:51], v[96:99], v[176:179], v[48:51]
  ds_read_b64_tr_b16 v[124:125], v19 offset:57344
  v_mfma_f32_16x16x32_bf16 v[52:55], v[96:99], v[180:183], v[52:55]
  ds_read_b64_tr_b16 v[126:127], v19 offset:58368
  v_mfma_f32_16x16x32_bf16 v[48:51], v[100:103], v[184:187], v[48:51]
  ds_read_b64_tr_b16 v[96:97], v20 offset:16384
  v_mfma_f32_16x16x32_bf16 v[52:55], v[100:103], v[188:191], v[52:55]
  ds_read_b64_tr_b16 v[98:99], v20 offset:17408
  s_waitcnt lgkmcnt(10)
  v_mfma_f32_16x16x32_bf16 v[56:59], v[104:107], v[144:147], v[56:59]
  ds_read_b64_tr_b16 v[100:101], v20 offset:24576
  v_mfma_f32_16x16x32_bf16 v[60:63], v[104:107], v[148:151], v[60:63]
  ds_read_b64_tr_b16 v[102:103], v20 offset:25600
  v_mfma_f32_16x16x32_bf16 v[56:59], v[108:111], v[152:155], v[56:59]
  ds_read_b64_tr_b16 v[104:105], v20 offset:32768
  v_mfma_f32_16x16x32_bf16 v[60:63], v[108:111], v[156:159], v[60:63]
  ds_read_b64_tr_b16 v[106:107], v20 offset:33792
  s_waitcnt lgkmcnt(10)
  v_mfma_f32_16x16x32_bf16 v[56:59], v[112:115], v[160:163], v[56:59]
  ds_read_b64_tr_b16 v[108:109], v20 offset:40960
  v_mfma_f32_16x16x32_bf16 v[60:63], v[112:115], v[164:167], v[60:63]
  ds_read_b64_tr_b16 v[110:111], v20 offset:41984
  v_mfma_f32_16x16x32_bf16 v[56:59], v[116:119], v[168:171], v[56:59]
  ds_read_b64_tr_b16 v[112:113], v20 offset:49152
  v_mfma_f32_16x16x32_bf16 v[60:63], v[116:119], v[172:175], v[60:63]
  ds_read_b64_tr_b16 v[114:115], v20 offset:50176
  s_waitcnt lgkmcnt(10)
  v_mfma_f32_16x16x32_bf16 v[56:59], v[120:123], v[176:179], v[56:59]
  ds_read_b64_tr_b16 v[116:117], v20 offset:57344
  v_mfma_f32_16x16x32_bf16 v[60:63], v[120:123], v[180:183], v[60:63]
  ds_read_b64_tr_b16 v[118:119], v20 offset:58368
  v_mfma_f32_16x16x32_bf16 v[56:59], v[124:127], v[184:187], v[56:59]
  ds_read_b64_tr_b16 v[120:121], v21 offset:16384
  v_mfma_f32_16x16x32_bf16 v[60:63], v[124:127], v[188:191], v[60:63]
  ds_read_b64_tr_b16 v[122:123], v21 offset:17408
  s_waitcnt lgkmcnt(10)
  v_mfma_f32_16x16x32_bf16 v[64:67], v[96:99], v[144:147], v[64:67]
  ds_read_b64_tr_b16 v[124:125], v21 offset:24576
  v_mfma_f32_16x16x32_bf16 v[68:71], v[96:99], v[148:151], v[68:71]
  ds_read_b64_tr_b16 v[126:127], v21 offset:25600
  v_mfma_f32_16x16x32_bf16 v[64:67], v[100:103], v[152:155], v[64:67]
  ds_read_b64_tr_b16 v[96:97], v21 offset:32768
  v_mfma_f32_16x16x32_bf16 v[68:71], v[100:103], v[156:159], v[68:71]
  ds_read_b64_tr_b16 v[98:99], v21 offset:33792
  s_waitcnt lgkmcnt(10)
  v_mfma_f32_16x16x32_bf16 v[64:67], v[104:107], v[160:163], v[64:67]
  ds_read_b64_tr_b16 v[100:101], v21 offset:40960
  v_mfma_f32_16x16x32_bf16 v[68:71], v[104:107], v[164:167], v[68:71]
  ds_read_b64_tr_b16 v[102:103], v21 offset:41984
  v_mfma_f32_16x16x32_bf16 v[64:67], v[108:111], v[168:171], v[64:67]
  ds_read_b64_tr_b16 v[104:105], v21 offset:49152
  v_mfma_f32_16x16x32_bf16 v[68:71], v[108:111], v[172:175], v[68:71]
  ds_read_b64_tr_b16 v[106:107], v21 offset:50176
  s_waitcnt lgkmcnt(10)
  v_mfma_f32_16x16x32_bf16 v[64:67], v[112:115], v[176:179], v[64:67]
  ds_read_b64_tr_b16 v[108:109], v21 offset:57344
  v_mfma_f32_16x16x32_bf16 v[68:71], v[112:115], v[180:183], v[68:71]
  ds_read_b64_tr_b16 v[110:111], v21 offset:58368
  v_mfma_f32_16x16x32_bf16 v[64:67], v[116:119], v[184:187], v[64:67]
  ds_read_b64_tr_b16 v[112:113], v22 offset:16384
  v_mfma_f32_16x16x32_bf16 v[68:71], v[116:119], v[188:191], v[68:71]
  ds_read_b64_tr_b16 v[114:115], v22 offset:17408
  s_waitcnt lgkmcnt(10)
  v_mfma_f32_16x16x32_bf16 v[72:75], v[120:123], v[144:147], v[72:75]
  ds_read_b64_tr_b16 v[116:117], v22 offset:24576
  v_mfma_f32_16x16x32_bf16 v[76:79], v[120:123], v[148:151], v[76:79]
  ds_read_b64_tr_b16 v[118:119], v22 offset:25600
  v_mfma_f32_16x16x32_bf16 v[72:75], v[124:127], v[152:155], v[72:75]
  ds_read_b64_tr_b16 v[120:121], v22 offset:32768
  v_mfma_f32_16x16x32_bf16 v[76:79], v[124:127], v[156:159], v[76:79]
  ds_read_b64_tr_b16 v[122:123], v22 offset:33792
  s_waitcnt lgkmcnt(10)
  v_mfma_f32_16x16x32_bf16 v[72:75], v[96:99], v[160:163], v[72:75]
  ds_read_b64_tr_b16 v[124:125], v22 offset:40960
  v_mfma_f32_16x16x32_bf16 v[76:79], v[96:99], v[164:167], v[76:79]
  ds_read_b64_tr_b16 v[126:127], v22 offset:41984
  v_mfma_f32_16x16x32_bf16 v[72:75], v[100:103], v[168:171], v[72:75]
  ds_read_b64_tr_b16 v[96:97], v22 offset:49152
  v_mfma_f32_16x16x32_bf16 v[76:79], v[100:103], v[172:175], v[76:79]
  ds_read_b64_tr_b16 v[98:99], v22 offset:50176
  s_waitcnt lgkmcnt(10)
  v_mfma_f32_16x16x32_bf16 v[72:75], v[104:107], v[176:179], v[72:75]
  ds_read_b64_tr_b16 v[100:101], v22 offset:57344
  v_mfma_f32_16x16x32_bf16 v[76:79], v[104:107], v[180:183], v[76:79]
  ds_read_b64_tr_b16 v[102:103], v22 offset:58368
  v_mfma_f32_16x16x32_bf16 v[72:75], v[108:111], v[184:187], v[72:75]
  ds_read_b64_tr_b16 v[104:105], v23 offset:16384
  v_mfma_f32_16x16x32_bf16 v[76:79], v[108:111], v[188:191], v[76:79]
  ds_read_b64_tr_b16 v[106:107], v23 offset:17408
  s_waitcnt lgkmcnt(10)
  v_mfma_f32_16x16x32_bf16 v[80:83], v[112:115], v[144:147], v[80:83]
  ds_read_b64_tr_b16 v[108:109], v23 offset:24576
  v_mfma_f32_16x16x32_bf16 v[84:87], v[112:115], v[148:151], v[84:87]
  ds_read_b64_tr_b16 v[110:111], v23 offset:25600
  v_mfma_f32_16x16x32_bf16 v[80:83], v[116:119], v[152:155], v[80:83]
  ds_read_b64_tr_b16 v[112:113], v23 offset:32768
  v_mfma_f32_16x16x32_bf16 v[84:87], v[116:119], v[156:159], v[84:87]
  ds_read_b64_tr_b16 v[114:115], v23 offset:33792
  s_waitcnt lgkmcnt(10)
  v_mfma_f32_16x16x32_bf16 v[80:83], v[120:123], v[160:163], v[80:83]
  ds_read_b64_tr_b16 v[116:117], v23 offset:40960
  v_mfma_f32_16x16x32_bf16 v[84:87], v[120:123], v[164:167], v[84:87]
  ds_read_b64_tr_b16 v[118:119], v23 offset:41984
  v_mfma_f32_16x16x32_bf16 v[80:83], v[124:127], v[168:171], v[80:83]
  ds_read_b64_tr_b16 v[120:121], v23 offset:49152
  v_mfma_f32_16x16x32_bf16 v[84:87], v[124:127], v[172:175], v[84:87]
  ds_read_b64_tr_b16 v[122:123], v23 offset:50176
  s_waitcnt lgkmcnt(10)
  v_mfma_f32_16x16x32_bf16 v[80:83], v[96:99], v[176:179], v[80:83]
  ds_read_b64_tr_b16 v[124:125], v23 offset:57344
  v_mfma_f32_16x16x32_bf16 v[84:87], v[96:99], v[180:183], v[84:87]
  ds_read_b64_tr_b16 v[126:127], v23 offset:58368
  v_mfma_f32_16x16x32_bf16 v[80:83], v[100:103], v[184:187], v[80:83]
  v_mfma_f32_16x16x32_bf16 v[84:87], v[100:103], v[188:191], v[84:87]
  s_waitcnt lgkmcnt(8)
  v_mfma_f32_16x16x32_bf16 v[88:91], v[104:107], v[144:147], v[88:91]
  v_mfma_f32_16x16x32_bf16 v[92:95], v[104:107], v[148:151], v[92:95]
  v_mfma_f32_16x16x32_bf16 v[88:91], v[108:111], v[152:155], v[88:91]
  v_mfma_f32_16x16x32_bf16 v[92:95], v[108:111], v[156:159], v[92:95]
  s_waitcnt lgkmcnt(4)
  v_mfma_f32_16x16x32_bf16 v[88:91], v[112:115], v[160:163], v[88:91]
  v_mfma_f32_16x16x32_bf16 v[92:95], v[112:115], v[164:167], v[92:95]
  v_mfma_f32_16x16x32_bf16 v[88:91], v[116:119], v[168:171], v[88:91]
  v_mfma_f32_16x16x32_bf16 v[92:95], v[116:119], v[172:175], v[92:95]
  s_waitcnt lgkmcnt(0)
  v_mfma_f32_16x16x32_bf16 v[88:91], v[120:123], v[176:179], v[88:91]
  v_mfma_f32_16x16x32_bf16 v[92:95], v[120:123], v[180:183], v[92:95]
  v_mfma_f32_16x16x32_bf16 v[88:91], v[124:127], v[184:187], v[88:91]
  v_mfma_f32_16x16x32_bf16 v[92:95], v[124:127], v[188:191], v[92:95]
  s_nop 7
  v_pk_mul_f32 v[128:129], v[32:33], v[32:33]
  v_pk_mul_f32 v[136:137], v[40:41], v[40:41]
  v_pk_mul_f32 v[130:131], v[34:35], v[34:35]
  v_pk_mul_f32 v[138:139], v[42:43], v[42:43]
  v_pk_mul_f32 v[132:133], v[36:37], v[36:37]
  v_pk_mul_f32 v[140:141], v[44:45], v[44:45]
  v_pk_mul_f32 v[134:135], v[38:39], v[38:39]
  v_pk_mul_f32 v[142:143], v[46:47], v[46:47]
  v_pk_fma_f32 v[128:129], v[128:129], v[210:211], v[208:209]
  v_pk_fma_f32 v[136:137], v[136:137], v[210:211], v[208:209]
  v_pk_fma_f32 v[130:131], v[130:131], v[210:211], v[208:209]
  v_pk_fma_f32 v[138:139], v[138:139], v[210:211], v[208:209]
  v_pk_fma_f32 v[132:133], v[132:133], v[210:211], v[208:209]
  v_pk_fma_f32 v[140:141], v[140:141], v[210:211], v[208:209]
  v_pk_fma_f32 v[134:135], v[134:135], v[210:211], v[208:209]
  v_pk_fma_f32 v[142:143], v[142:143], v[210:211], v[208:209]
  v_pk_mul_f32 v[128:129], v[128:129], v[32:33]
  v_pk_mul_f32 v[136:137], v[136:137], v[40:41]
  v_pk_mul_f32 v[130:131], v[130:131], v[34:35]
  v_pk_mul_f32 v[138:139], v[138:139], v[42:43]
  v_pk_mul_f32 v[132:133], v[132:133], v[36:37]
  v_pk_mul_f32 v[140:141], v[140:141], v[44:45]
  v_pk_mul_f32 v[134:135], v[134:135], v[38:39]
  v_pk_mul_f32 v[142:143], v[142:143], v[46:47]
  v_exp_f32 v128, v128
  v_exp_f32 v136, v136
  v_exp_f32 v129, v129
  v_exp_f32 v137, v137
  v_exp_f32 v130, v130
  v_exp_f32 v138, v138
  v_exp_f32 v131, v131
  v_exp_f32 v139, v139
  v_exp_f32 v132, v132
  v_exp_f32 v140, v140
  v_exp_f32 v133, v133
  v_exp_f32 v141, v141
  v_exp_f32 v134, v134
  v_exp_f32 v142, v142
  v_exp_f32 v135, v135
  v_exp_f32 v143, v143
  v_pk_add_f32 v[128:129], v[128:129], 1.0 op_sel_hi:[1,0]
  v_pk_add_f32 v[136:137], v[136:137], 1.0 op_sel_hi:[1,0]
  v_pk_add_f32 v[130:131], v[130:131], 1.0 op_sel_hi:[1,0]
  v_pk_add_f32 v[138:139], v[138:139], 1.0 op_sel_hi:[1,0]
  v_pk_add_f32 v[132:133], v[132:133], 1.0 op_sel_hi:[1,0]
  v_pk_add_f32 v[140:141], v[140:141], 1.0 op_sel_hi:[1,0]
  v_pk_add_f32 v[134:135], v[134:135], 1.0 op_sel_hi:[1,0]
  v_pk_add_f32 v[142:143], v[142:143], 1.0 op_sel_hi:[1,0]
  v_rcp_f32 v128, v128
  v_rcp_f32 v136, v136
  v_rcp_f32 v129, v129
  v_rcp_f32 v137, v137
  v_rcp_f32 v130, v130
  v_rcp_f32 v138, v138
  v_rcp_f32 v131, v131
  v_rcp_f32 v139, v139
  v_rcp_f32 v132, v132
  v_rcp_f32 v140, v140
  v_rcp_f32 v133, v133
  v_rcp_f32 v141, v141
  v_rcp_f32 v134, v134
  v_rcp_f32 v142, v142
  v_rcp_f32 v135, v135
  v_rcp_f32 v143, v143
  v_pk_mul_f32 v[128:129], v[32:33], v[128:129]
  v_pk_mul_f32 v[136:137], v[40:41], v[136:137]
  v_pk_mul_f32 v[130:131], v[34:35], v[130:131]
  v_pk_mul_f32 v[138:139], v[42:43], v[138:139]
  v_pk_mul_f32 v[132:133], v[36:37], v[132:133]
  v_pk_mul_f32 v[140:141], v[44:45], v[140:141]
  v_pk_mul_f32 v[134:135], v[38:39], v[134:135]
  v_pk_mul_f32 v[142:143], v[46:47], v[142:143]
  v_cvt_pk_bf16_f32 v144, v128, v129
  v_cvt_pk_bf16_f32 v148, v136, v137
  v_cvt_pk_bf16_f32 v145, v130, v131
  v_cvt_pk_bf16_f32 v149, v138, v139
  v_cvt_pk_bf16_f32 v146, v132, v133
  v_cvt_pk_bf16_f32 v150, v140, v141
  v_cvt_pk_bf16_f32 v147, v134, v135
  v_cvt_pk_bf16_f32 v151, v142, v143
  s_mov_b32 s47, 0
  s_mov_b32 s48, 1024
  s_nop 0
  s_nop 0
  v_permlane16_swap_b32 v144, v146
  v_permlane16_swap_b32 v148, v150
  v_permlane16_swap_b32 v145, v147
  v_permlane16_swap_b32 v149, v151
  buffer_store_dwordx4 v[144:147], v28, s[32:35], s47 offen sc1
  buffer_store_dwordx4 v[148:151], v28, s[32:35], s48 offen sc1
  v_pk_mul_f32 v[128:129], v[48:49], v[48:49]
  v_pk_mul_f32 v[136:137], v[56:57], v[56:57]
  v_pk_mul_f32 v[130:131], v[50:51], v[50:51]
  v_pk_mul_f32 v[138:139], v[58:59], v[58:59]
  v_pk_mul_f32 v[132:133], v[52:53], v[52:53]
  v_pk_mul_f32 v[140:141], v[60:61], v[60:61]
  v_pk_mul_f32 v[134:135], v[54:55], v[54:55]
  v_pk_mul_f32 v[142:143], v[62:63], v[62:63]
  v_pk_fma_f32 v[128:129], v[128:129], v[210:211], v[208:209]
  v_pk_fma_f32 v[136:137], v[136:137], v[210:211], v[208:209]
  v_pk_fma_f32 v[130:131], v[130:131], v[210:211], v[208:209]
  v_pk_fma_f32 v[138:139], v[138:139], v[210:211], v[208:209]
  v_pk_fma_f32 v[132:133], v[132:133], v[210:211], v[208:209]
  v_pk_fma_f32 v[140:141], v[140:141], v[210:211], v[208:209]
  v_pk_fma_f32 v[134:135], v[134:135], v[210:211], v[208:209]
  v_pk_fma_f32 v[142:143], v[142:143], v[210:211], v[208:209]
  v_pk_mul_f32 v[128:129], v[128:129], v[48:49]
  v_pk_mul_f32 v[136:137], v[136:137], v[56:57]
  v_pk_mul_f32 v[130:131], v[130:131], v[50:51]
  v_pk_mul_f32 v[138:139], v[138:139], v[58:59]
  v_pk_mul_f32 v[132:133], v[132:133], v[52:53]
  v_pk_mul_f32 v[140:141], v[140:141], v[60:61]
  v_pk_mul_f32 v[134:135], v[134:135], v[54:55]
  v_pk_mul_f32 v[142:143], v[142:143], v[62:63]
  v_exp_f32 v128, v128
  v_exp_f32 v136, v136
  v_exp_f32 v129, v129
  v_exp_f32 v137, v137
  v_exp_f32 v130, v130
  v_exp_f32 v138, v138
  v_exp_f32 v131, v131
  v_exp_f32 v139, v139
  v_exp_f32 v132, v132
  v_exp_f32 v140, v140
  v_exp_f32 v133, v133
  v_exp_f32 v141, v141
  v_exp_f32 v134, v134
  v_exp_f32 v142, v142
  v_exp_f32 v135, v135
  v_exp_f32 v143, v143
  v_pk_add_f32 v[128:129], v[128:129], 1.0 op_sel_hi:[1,0]
  v_pk_add_f32 v[136:137], v[136:137], 1.0 op_sel_hi:[1,0]
  v_pk_add_f32 v[130:131], v[130:131], 1.0 op_sel_hi:[1,0]
  v_pk_add_f32 v[138:139], v[138:139], 1.0 op_sel_hi:[1,0]
  v_pk_add_f32 v[132:133], v[132:133], 1.0 op_sel_hi:[1,0]
  v_pk_add_f32 v[140:141], v[140:141], 1.0 op_sel_hi:[1,0]
  v_pk_add_f32 v[134:135], v[134:135], 1.0 op_sel_hi:[1,0]
  v_pk_add_f32 v[142:143], v[142:143], 1.0 op_sel_hi:[1,0]
  v_rcp_f32 v128, v128
  v_rcp_f32 v136, v136
  v_rcp_f32 v129, v129
  v_rcp_f32 v137, v137
  v_rcp_f32 v130, v130
  v_rcp_f32 v138, v138
  v_rcp_f32 v131, v131
  v_rcp_f32 v139, v139
  v_rcp_f32 v132, v132
  v_rcp_f32 v140, v140
  v_rcp_f32 v133, v133
  v_rcp_f32 v141, v141
  v_rcp_f32 v134, v134
  v_rcp_f32 v142, v142
  v_rcp_f32 v135, v135
  v_rcp_f32 v143, v143
  v_pk_mul_f32 v[128:129], v[48:49], v[128:129]
  v_pk_mul_f32 v[136:137], v[56:57], v[136:137]
  v_pk_mul_f32 v[130:131], v[50:51], v[130:131]
  v_pk_mul_f32 v[138:139], v[58:59], v[138:139]
  v_pk_mul_f32 v[132:133], v[52:53], v[132:133]
  v_pk_mul_f32 v[140:141], v[60:61], v[140:141]
  v_pk_mul_f32 v[134:135], v[54:55], v[134:135]
  v_pk_mul_f32 v[142:143], v[62:63], v[142:143]
  v_cvt_pk_bf16_f32 v144, v128, v129
  v_cvt_pk_bf16_f32 v148, v136, v137
  v_cvt_pk_bf16_f32 v145, v130, v131
  v_cvt_pk_bf16_f32 v149, v138, v139
  v_cvt_pk_bf16_f32 v146, v132, v133
  v_cvt_pk_bf16_f32 v150, v140, v141
  v_cvt_pk_bf16_f32 v147, v134, v135
  v_cvt_pk_bf16_f32 v151, v142, v143
  s_mov_b32 s47, 2048
  s_mov_b32 s48, 3072
  s_nop 0
  s_nop 0
  v_permlane16_swap_b32 v144, v146
  v_permlane16_swap_b32 v148, v150
  v_permlane16_swap_b32 v145, v147
  v_permlane16_swap_b32 v149, v151
  buffer_store_dwordx4 v[144:147], v28, s[32:35], s47 offen sc1
  buffer_store_dwordx4 v[148:151], v28, s[32:35], s48 offen sc1
  v_pk_mul_f32 v[128:129], v[64:65], v[64:65]
  v_pk_mul_f32 v[136:137], v[72:73], v[72:73]
  v_pk_mul_f32 v[130:131], v[66:67], v[66:67]
  v_pk_mul_f32 v[138:139], v[74:75], v[74:75]
  v_pk_mul_f32 v[132:133], v[68:69], v[68:69]
  v_pk_mul_f32 v[140:141], v[76:77], v[76:77]
  v_pk_mul_f32 v[134:135], v[70:71], v[70:71]
  v_pk_mul_f32 v[142:143], v[78:79], v[78:79]
  v_pk_fma_f32 v[128:129], v[128:129], v[210:211], v[208:209]
  v_pk_fma_f32 v[136:137], v[136:137], v[210:211], v[208:209]
  v_pk_fma_f32 v[130:131], v[130:131], v[210:211], v[208:209]
  v_pk_fma_f32 v[138:139], v[138:139], v[210:211], v[208:209]
  v_pk_fma_f32 v[132:133], v[132:133], v[210:211], v[208:209]
  v_pk_fma_f32 v[140:141], v[140:141], v[210:211], v[208:209]
  v_pk_fma_f32 v[134:135], v[134:135], v[210:211], v[208:209]
  v_pk_fma_f32 v[142:143], v[142:143], v[210:211], v[208:209]
  v_pk_mul_f32 v[128:129], v[128:129], v[64:65]
  v_pk_mul_f32 v[136:137], v[136:137], v[72:73]
  v_pk_mul_f32 v[130:131], v[130:131], v[66:67]
  v_pk_mul_f32 v[138:139], v[138:139], v[74:75]
  v_pk_mul_f32 v[132:133], v[132:133], v[68:69]
  v_pk_mul_f32 v[140:141], v[140:141], v[76:77]
  v_pk_mul_f32 v[134:135], v[134:135], v[70:71]
  v_pk_mul_f32 v[142:143], v[142:143], v[78:79]
  v_exp_f32 v128, v128
  v_exp_f32 v136, v136
  v_exp_f32 v129, v129
  v_exp_f32 v137, v137
  v_exp_f32 v130, v130
  v_exp_f32 v138, v138
  v_exp_f32 v131, v131
  v_exp_f32 v139, v139
  v_exp_f32 v132, v132
  v_exp_f32 v140, v140
  v_exp_f32 v133, v133
  v_exp_f32 v141, v141
  v_exp_f32 v134, v134
  v_exp_f32 v142, v142
  v_exp_f32 v135, v135
  v_exp_f32 v143, v143
  v_pk_add_f32 v[128:129], v[128:129], 1.0 op_sel_hi:[1,0]
  v_pk_add_f32 v[136:137], v[136:137], 1.0 op_sel_hi:[1,0]
  v_pk_add_f32 v[130:131], v[130:131], 1.0 op_sel_hi:[1,0]
  v_pk_add_f32 v[138:139], v[138:139], 1.0 op_sel_hi:[1,0]
  v_pk_add_f32 v[132:133], v[132:133], 1.0 op_sel_hi:[1,0]
  v_pk_add_f32 v[140:141], v[140:141], 1.0 op_sel_hi:[1,0]
  v_pk_add_f32 v[134:135], v[134:135], 1.0 op_sel_hi:[1,0]
  v_pk_add_f32 v[142:143], v[142:143], 1.0 op_sel_hi:[1,0]
  v_rcp_f32 v128, v128
  v_rcp_f32 v136, v136
  v_rcp_f32 v129, v129
  v_rcp_f32 v137, v137
  v_rcp_f32 v130, v130
  v_rcp_f32 v138, v138
  v_rcp_f32 v131, v131
  v_rcp_f32 v139, v139
  v_rcp_f32 v132, v132
  v_rcp_f32 v140, v140
  v_rcp_f32 v133, v133
  v_rcp_f32 v141, v141
  v_rcp_f32 v134, v134
  v_rcp_f32 v142, v142
  v_rcp_f32 v135, v135
  v_rcp_f32 v143, v143
  v_pk_mul_f32 v[128:129], v[64:65], v[128:129]
  v_pk_mul_f32 v[136:137], v[72:73], v[136:137]
  v_pk_mul_f32 v[130:131], v[66:67], v[130:131]
  v_pk_mul_f32 v[138:139], v[74:75], v[138:139]
  v_pk_mul_f32 v[132:133], v[68:69], v[132:133]
  v_pk_mul_f32 v[140:141], v[76:77], v[140:141]
  v_pk_mul_f32 v[134:135], v[70:71], v[134:135]
  v_pk_mul_f32 v[142:143], v[78:79], v[142:143]
  v_cvt_pk_bf16_f32 v144, v128, v129
  v_cvt_pk_bf16_f32 v148, v136, v137
  v_cvt_pk_bf16_f32 v145, v130, v131
  v_cvt_pk_bf16_f32 v149, v138, v139
  v_cvt_pk_bf16_f32 v146, v132, v133
  v_cvt_pk_bf16_f32 v150, v140, v141
  v_cvt_pk_bf16_f32 v147, v134, v135
  v_cvt_pk_bf16_f32 v151, v142, v143
  s_mov_b32 s47, 4096
  s_mov_b32 s48, 5120
  s_nop 0
  s_nop 0
  v_permlane16_swap_b32 v144, v146
  v_permlane16_swap_b32 v148, v150
  v_permlane16_swap_b32 v145, v147
  v_permlane16_swap_b32 v149, v151
  buffer_store_dwordx4 v[144:147], v28, s[32:35], s47 offen sc1
  buffer_store_dwordx4 v[148:151], v28, s[32:35], s48 offen sc1
  v_pk_mul_f32 v[128:129], v[80:81], v[80:81]
  v_pk_mul_f32 v[136:137], v[88:89], v[88:89]
  v_pk_mul_f32 v[130:131], v[82:83], v[82:83]
  v_pk_mul_f32 v[138:139], v[90:91], v[90:91]
  v_pk_mul_f32 v[132:133], v[84:85], v[84:85]
  v_pk_mul_f32 v[140:141], v[92:93], v[92:93]
  v_pk_mul_f32 v[134:135], v[86:87], v[86:87]
  v_pk_mul_f32 v[142:143], v[94:95], v[94:95]
  v_pk_fma_f32 v[128:129], v[128:129], v[210:211], v[208:209]
  v_pk_fma_f32 v[136:137], v[136:137], v[210:211], v[208:209]
  v_pk_fma_f32 v[130:131], v[130:131], v[210:211], v[208:209]
  v_pk_fma_f32 v[138:139], v[138:139], v[210:211], v[208:209]
  v_pk_fma_f32 v[132:133], v[132:133], v[210:211], v[208:209]
  v_pk_fma_f32 v[140:141], v[140:141], v[210:211], v[208:209]
  v_pk_fma_f32 v[134:135], v[134:135], v[210:211], v[208:209]
  v_pk_fma_f32 v[142:143], v[142:143], v[210:211], v[208:209]
  v_pk_mul_f32 v[128:129], v[128:129], v[80:81]
  v_pk_mul_f32 v[136:137], v[136:137], v[88:89]
  v_pk_mul_f32 v[130:131], v[130:131], v[82:83]
  v_pk_mul_f32 v[138:139], v[138:139], v[90:91]
  v_pk_mul_f32 v[132:133], v[132:133], v[84:85]
  v_pk_mul_f32 v[140:141], v[140:141], v[92:93]
  v_pk_mul_f32 v[134:135], v[134:135], v[86:87]
  v_pk_mul_f32 v[142:143], v[142:143], v[94:95]
  v_exp_f32 v128, v128
  v_exp_f32 v136, v136
  v_exp_f32 v129, v129
  v_exp_f32 v137, v137
  v_exp_f32 v130, v130
  v_exp_f32 v138, v138
  v_exp_f32 v131, v131
  v_exp_f32 v139, v139
  v_exp_f32 v132, v132
  v_exp_f32 v140, v140
  v_exp_f32 v133, v133
  v_exp_f32 v141, v141
  v_exp_f32 v134, v134
  v_exp_f32 v142, v142
  v_exp_f32 v135, v135
  v_exp_f32 v143, v143
  v_pk_add_f32 v[128:129], v[128:129], 1.0 op_sel_hi:[1,0]
  v_pk_add_f32 v[136:137], v[136:137], 1.0 op_sel_hi:[1,0]
  v_pk_add_f32 v[130:131], v[130:131], 1.0 op_sel_hi:[1,0]
  v_pk_add_f32 v[138:139], v[138:139], 1.0 op_sel_hi:[1,0]
  v_pk_add_f32 v[132:133], v[132:133], 1.0 op_sel_hi:[1,0]
  v_pk_add_f32 v[140:141], v[140:141], 1.0 op_sel_hi:[1,0]
  v_pk_add_f32 v[134:135], v[134:135], 1.0 op_sel_hi:[1,0]
  v_pk_add_f32 v[142:143], v[142:143], 1.0 op_sel_hi:[1,0]
  v_rcp_f32 v128, v128
  v_rcp_f32 v136, v136
  v_rcp_f32 v129, v129
  v_rcp_f32 v137, v137
  v_rcp_f32 v130, v130
  v_rcp_f32 v138, v138
  v_rcp_f32 v131, v131
  v_rcp_f32 v139, v139
  v_rcp_f32 v132, v132
  v_rcp_f32 v140, v140
  v_rcp_f32 v133, v133
  v_rcp_f32 v141, v141
  v_rcp_f32 v134, v134
  v_rcp_f32 v142, v142
  v_rcp_f32 v135, v135
  v_rcp_f32 v143, v143
  v_pk_mul_f32 v[128:129], v[80:81], v[128:129]
  v_pk_mul_f32 v[136:137], v[88:89], v[136:137]
  v_pk_mul_f32 v[130:131], v[82:83], v[130:131]
  v_pk_mul_f32 v[138:139], v[90:91], v[138:139]
  v_pk_mul_f32 v[132:133], v[84:85], v[132:133]
  v_pk_mul_f32 v[140:141], v[92:93], v[140:141]
  v_pk_mul_f32 v[134:135], v[86:87], v[134:135]
  v_pk_mul_f32 v[142:143], v[94:95], v[142:143]
  v_cvt_pk_bf16_f32 v144, v128, v129
  v_cvt_pk_bf16_f32 v148, v136, v137
  v_cvt_pk_bf16_f32 v145, v130, v131
  v_cvt_pk_bf16_f32 v149, v138, v139
  v_cvt_pk_bf16_f32 v146, v132, v133
  v_cvt_pk_bf16_f32 v150, v140, v141
  v_cvt_pk_bf16_f32 v147, v134, v135
  v_cvt_pk_bf16_f32 v151, v142, v143
  s_mov_b32 s47, 6144
  s_mov_b32 s48, 7168
  s_nop 0
  s_nop 0
  v_permlane16_swap_b32 v144, v146
  v_permlane16_swap_b32 v148, v150
  v_permlane16_swap_b32 v145, v147
  v_permlane16_swap_b32 v149, v151
  buffer_store_dwordx4 v[144:147], v28, s[32:35], s47 offen sc1
  buffer_store_dwordx4 v[148:151], v28, s[32:35], s48 offen sc1
  s_waitcnt vmcnt(0)
  s_branch g1_join
g1_loader:
  s_sub_u32 s50, s20, 4
  s_lshl_b32 s49, s50, 10
  s_add_u32 s7, s49, 131072
  s_barrier
  s_waitcnt vmcnt(4)
  s_barrier
  s_add_u32 m0, s5, 0
  s_nop 0
  buffer_load_dwordx4 v224, s[28:31], s4 offen lds
  s_add_u32 m0, s5, 4096
  s_nop 0
  buffer_load_dwordx4 v225, s[28:31], s4 offen lds
  s_add_u32 m0, s5, 8192
  s_nop 0
  buffer_load_dwordx4 v226, s[28:31], s4 offen lds
  s_add_u32 m0, s5, 12288
  s_nop 0
  buffer_load_dwordx4 v227, s[28:31], s4 offen lds
  s_add_u32 s4, s4, s9
  s_add_u32 s5, s5, 16384
  s_cmp_ge_u32 s5, s7
  s_cselect_b32 s8, 131072, 0
  s_sub_u32 s5, s5, s8
  s_add_u32 m0, s5, 0
  s_nop 0
  buffer_load_dwordx4 v224, s[28:31], s4 offen lds
  s_add_u32 m0, s5, 4096
  s_nop 0
  buffer_load_dwordx4 v225, s[28:31], s4 offen lds
  s_add_u32 m0, s5, 8192
  s_nop 0
  buffer_load_dwordx4 v226, s[28:31], s4 offen lds
  s_add_u32 m0, s5, 12288
  s_nop 0
  buffer_load_dwordx4 v227, s[28:31], s4 offen lds
  s_add_u32 s4, s4, s9
  s_add_u32 s5, s5, 16384
  s_cmp_ge_u32 s5, s7
  s_cselect_b32 s8, 131072, 0
  s_sub_u32 s5, s5, s8
  s_add_u32 m0, s5, 0
  s_nop 0
  buffer_load_dwordx4 v224, s[28:31], s4 offen lds
  s_add_u32 m0, s5, 4096
  s_nop 0
  buffer_load_dwordx4 v225, s[28:31], s4 offen lds
  s_add_u32 m0, s5, 8192
  s_nop 0
  buffer_load_dwordx4 v226, s[28:31], s4 offen lds
  s_add_u32 m0, s5, 12288
  s_nop 0
  buffer_load_dwordx4 v227, s[28:31], s4 offen lds
  s_add_u32 s4, s4, s9
  s_add_u32 s5, s5, 16384
  s_cmp_ge_u32 s5, s7
  s_cselect_b32 s8, 131072, 0
  s_sub_u32 s5, s5, s8
  s_add_u32 m0, s5, 0
  s_nop 0
  buffer_load_dwordx4 v224, s[28:31], s4 offen lds
  s_add_u32 m0, s5, 4096
  s_nop 0
  buffer_load_dwordx4 v225, s[28:31], s4 offen lds
  s_add_u32 m0, s5, 8192
  s_nop 0
  buffer_load_dwordx4 v226, s[28:31], s4 offen lds
  s_add_u32 m0, s5, 12288
  s_nop 0
  buffer_load_dwordx4 v227, s[28:31], s4 offen lds
  s_add_u32 s4, s4, s9
  s_add_u32 s5, s5, 16384
  s_cmp_ge_u32 s5, s7
  s_cselect_b32 s8, 131072, 0
  s_sub_u32 s5, s5, s8
  s_add_u32 m0, s5, 0
  s_nop 0
  buffer_load_dwordx4 v224, s[28:31], s4 offen lds
  s_add_u32 m0, s5, 4096
  s_nop 0
  buffer_load_dwordx4 v225, s[28:31], s4 offen lds
  s_add_u32 m0, s5, 8192
  s_nop 0
  buffer_load_dwordx4 v226, s[28:31], s4 offen lds
  s_add_u32 m0, s5, 12288
  s_nop 0
  buffer_load_dwordx4 v227, s[28:31], s4 offen lds
  s_add_u32 s4, s4, s9
  s_add_u32 s5, s5, 16384
  s_cmp_ge_u32 s5, s7
  s_cselect_b32 s8, 131072, 0
  s_sub_u32 s5, s5, s8
  s_mov_b32 s6, 25
g1_lloop:
  s_waitcnt vmcnt(20)
  s_barrier
  s_add_u32 m0, s5, 0
  s_nop 0
  buffer_load_dwordx4 v224, s[28:31], s4 offen lds
  s_add_u32 m0, s5, 4096
  s_nop 0
  buffer_load_dwordx4 v225, s[28:31], s4 offen lds
  s_add_u32 m0, s5, 8192
  s_nop 0
  buffer_load_dwordx4 v226, s[28:31], s4 offen lds
  s_add_u32 m0, s5, 12288
  s_nop 0
  buffer_load_dwordx4 v227, s[28:31], s4 offen lds
  s_add_u32 s4, s4, s9
  s_add_u32 s5, s5, 16384
  s_cmp_ge_u32 s5, s7
  s_cselect_b32 s8, 131072, 0
  s_sub_u32 s5, s5, s8
  s_sub_u32 s6, s6, 1
  s_cmp_lg_u32 s6, 0
  s_cbranch_scc1 g1_lloop
  s_waitcnt vmcnt(20)
  s_barrier
  s_waitcnt vmcnt(16)
  s_barrier
  s_waitcnt vmcnt(12)
  s_barrier
  s_waitcnt vmcnt(8)
  s_barrier
  s_waitcnt vmcnt(4)
  s_barrier
  s_waitcnt vmcnt(0)
  s_barrier
  s_lshr_b32 s47, s2, 3
  s_lshr_b32 s44, s47, 2
  s_lshr_b32 s46, s2, 1
  s_and_b32 s46, s46, 3
  s_lshl_b32 s46, s46, 2
  s_and_b32 s47, s47, 3
  s_add_u32 s45, s46, s47
  s_and_b32 s19, s2, 1
  s_mov_b32 s28, s74
  s_mov_b32 s29, s75
  s_mov_b32 s30, 14680064
  s_mov_b32 s31, 0x00020000
  s_sub_u32 s50, s20, 4
  s_lshl_b32 s49, s50, 2
  s_add_u32 s49, s49, 0
  v_lshrrev_b32 v14, 4, v7
  v_add_u32 v14, s49, v14
  v_and_b32 v15, 3, v14
  v_lshlrev_b32 v15, 2, v15
  v_bfe_u32 v16, v14, 3, 1
  v_lshl_add_u32 v15, v16, 1, v15
  v_and_b32 v16, 15, v7
  v_xor_b32 v16, v16, v15
  v_lshlrev_b32 v14, 12, v14
  v_lshl_add_u32 v14, v16, 4, v14
  s_lshl_b32 s49, s45, 8
  s_mul_i32 s48, s19, 7340032
  s_add_u32 s49, s49, s48
  v_add_u32 v224, s49, v14
  s_lshl_b32 s49, s50, 2
  s_add_u32 s49, s49, 16
  v_lshrrev_b32 v14, 4, v7
  v_add_u32 v14, s49, v14
  v_and_b32 v15, 3, v14
  v_lshlrev_b32 v15, 2, v15
  v_bfe_u32 v16, v14, 3, 1
  v_lshl_add_u32 v15, v16, 1, v15
  v_and_b32 v16, 15, v7
  v_xor_b32 v16, v16, v15
  v_lshlrev_b32 v14, 12, v14
  v_lshl_add_u32 v14, v16, 4, v14
  s_lshl_b32 s49, s45, 8
  s_mul_i32 s48, s19, 7340032
  s_add_u32 s49, s49, s48
  v_add_u32 v225, s49, v14
  s_lshl_b32 s49, s50, 2
  s_add_u32 s49, s49, 32
  v_lshrrev_b32 v14, 4, v7
  v_add_u32 v14, s49, v14
  v_and_b32 v15, 3, v14
  v_lshlrev_b32 v15, 2, v15
  v_bfe_u32 v16, v14, 3, 1
  v_lshl_add_u32 v15, v16, 1, v15
  v_and_b32 v16, 15, v7
  v_xor_b32 v16, v16, v15
  v_lshlrev_b32 v14, 12, v14
  v_lshl_add_u32 v14, v16, 4, v14
  s_lshl_b32 s49, s45, 8
  s_mul_i32 s48, s19, 7340032
  s_add_u32 s49, s49, s48
  v_add_u32 v226, s49, v14
  s_lshl_b32 s49, s50, 2
  s_add_u32 s49, s49, 48
  v_lshrrev_b32 v14, 4, v7
  v_add_u32 v14, s49, v14
  v_and_b32 v15, 3, v14
  v_lshlrev_b32 v15, 2, v15
  v_bfe_u32 v16, v14, 3, 1
  v_lshl_add_u32 v15, v16, 1, v15
  v_and_b32 v16, 15, v7
  v_xor_b32 v16, v16, v15
  v_lshlrev_b32 v14, 12, v14
  v_lshl_add_u32 v14, v16, 4, v14
  s_lshl_b32 s49, s45, 8
  s_mul_i32 s48, s19, 7340032
  s_add_u32 s49, s49, s48
  v_add_u32 v227, s49, v14
  s_sub_u32 s50, s20, 4
  s_lshl_b32 s5, s50, 10
  s_add_u32 s7, s5, 131072
  s_mov_b32 s4, 0
  s_mov_b32 s9, 262144
  s_add_u32 m0, s5, 0
  s_nop 0
  buffer_load_dwordx4 v224, s[28:31], s4 offen lds
  s_add_u32 m0, s5, 4096
  s_nop 0
  buffer_load_dwordx4 v225, s[28:31], s4 offen lds
  s_add_u32 m0, s5, 8192
  s_nop 0
  buffer_load_dwordx4 v226, s[28:31], s4 offen lds
  s_add_u32 m0, s5, 12288
  s_nop 0
  buffer_load_dwordx4 v227, s[28:31], s4 offen lds
  s_add_u32 s4, s4, s9
  s_add_u32 s5, s5, 16384
  s_cmp_ge_u32 s5, s7
  s_cselect_b32 s8, 131072, 0
  s_sub_u32 s5, s5, s8
  s_add_u32 m0, s5, 0
  s_nop 0
  buffer_load_dwordx4 v224, s[28:31], s4 offen lds
  s_add_u32 m0, s5, 4096
  s_nop 0
  buffer_load_dwordx4 v225, s[28:31], s4 offen lds
  s_add_u32 m0, s5, 8192
  s_nop 0
  buffer_load_dwordx4 v226, s[28:31], s4 offen lds
  s_add_u32 m0, s5, 12288
  s_nop 0
  buffer_load_dwordx4 v227, s[28:31], s4 offen lds
  s_add_u32 s4, s4, s9
  s_add_u32 s5, s5, 16384
  s_cmp_ge_u32 s5, s7
  s_cselect_b32 s8, 131072, 0
  s_sub_u32 s5, s5, s8
g1_join:
  s_cmp_ge_u32 s60, 14
  s_cselect_b32 s18, 1, 0
  s_lshl_b32 s10, s61, 1
  s_add_u32 s18, s18, s10
  s_barrier
  s_cmp_lg_u32 s20, 0
  s_cbranch_scc1 x4_arr_skip
  s_lshl_b32 s10, s18, 8
  s_add_u32 s10, s10, 12288
  v_mov_b32 v228, s10
  v_mov_b32 v229, 1
  s_mov_b64 s[16:17], exec
  s_mov_b64 exec, 1
  buffer_atomic_add v229, v228, s[12:15], 0 offen sc1
  s_mov_b64 exec, s[16:17]
x4_arr_skip:
  s_branch g2_start
g1_inactive:
  s_sub_u32 s50, s2, 224
  s_lshl_b32 s50, s50, 3
  s_add_u32 s50, s50, s20
  v_lshlrev_b32 v29, 4, v7
  s_mov_b32 s56, s74
  s_mov_b32 s57, s75
  s_mov_b32 s58, 14680064
  s_mov_b32 s59, 0x00020000
  s_mul_i32 s51, s50, 57344
  v_lshlrev_b32 v29, 7, v7
  buffer_load_dword v230, v29, s[56:59], s51 offen
  s_add_u32 s51, s51, 8192
  buffer_load_dword v230, v29, s[56:59], s51 offen
  s_add_u32 s51, s51, 8192
  s_waitcnt vmcnt(1)
  buffer_load_dword v230, v29, s[56:59], s51 offen
  s_add_u32 s51, s51, 8192
  s_waitcnt vmcnt(1)
  buffer_load_dword v230, v29, s[56:59], s51 offen
  s_add_u32 s51, s51, 8192
  s_waitcnt vmcnt(1)
  buffer_load_dword v230, v29, s[56:59], s51 offen
  s_add_u32 s51, s51, 8192
  s_waitcnt vmcnt(1)
  buffer_load_dword v230, v29, s[56:59], s51 offen
  s_add_u32 s51, s51, 8192
  s_waitcnt vmcnt(1)
  buffer_load_dword v230, v29, s[56:59], s51 offen
  s_add_u32 s51, s51, 8192
  s_waitcnt vmcnt(1)
  s_waitcnt vmcnt(0)
  s_cmp_lt_u32 s20, 4
  s_cbranch_scc1 g2_start_inactive
  s_lshr_b32 s47, s2, 3
  s_lshr_b32 s44, s47, 2
  s_lshr_b32 s46, s2, 1
  s_and_b32 s46, s46, 3
  s_lshl_b32 s46, s46, 2
  s_and_b32 s47, s47, 3
  s_add_u32 s45, s46, s47
  s_and_b32 s19, s2, 1
  s_mov_b32 s28, s74
  s_mov_b32 s29, s75
  s_mov_b32 s30, 14680064
  s_mov_b32 s31, 0x00020000
  s_sub_u32 s50, s20, 4
  s_lshl_b32 s49, s50, 2
  s_add_u32 s49, s49, 0
  v_lshrrev_b32 v14, 4, v7
  v_add_u32 v14, s49, v14
  v_and_b32 v15, 3, v14
  v_lshlrev_b32 v15, 2, v15
  v_bfe_u32 v16, v14, 3, 1
  v_lshl_add_u32 v15, v16, 1, v15
  v_and_b32 v16, 15, v7
  v_xor_b32 v16, v16, v15
  v_lshlrev_b32 v14, 12, v14
  v_lshl_add_u32 v14, v16, 4, v14
  s_lshl_b32 s49, s45, 8
  s_mul_i32 s48, s19, 7340032
  s_add_u32 s49, s49, s48
  v_add_u32 v224, s49, v14
  s_lshl_b32 s49, s50, 2
  s_add_u32 s49, s49, 16
  v_lshrrev_b32 v14, 4, v7
  v_add_u32 v14, s49, v14
  v_and_b32 v15, 3, v14
  v_lshlrev_b32 v15, 2, v15
  v_bfe_u32 v16, v14, 3, 1
  v_lshl_add_u32 v15, v16, 1, v15
  v_and_b32 v16, 15, v7
  v_xor_b32 v16, v16, v15
  v_lshlrev_b32 v14, 12, v14
  v_lshl_add_u32 v14, v16, 4, v14
  s_lshl_b32 s49, s45, 8
  s_mul_i32 s48, s19, 7340032
  s_add_u32 s49, s49, s48
  v_add_u32 v225, s49, v14
  s_lshl_b32 s49, s50, 2
  s_add_u32 s49, s49, 32
  v_lshrrev_b32 v14, 4, v7
  v_add_u32 v14, s49, v14
  v_and_b32 v15, 3, v14
  v_lshlrev_b32 v15, 2, v15
  v_bfe_u32 v16, v14, 3, 1
  v_lshl_add_u32 v15, v16, 1, v15
  v_and_b32 v16, 15, v7
  v_xor_b32 v16, v16, v15
  v_lshlrev_b32 v14, 12, v14
  v_lshl_add_u32 v14, v16, 4, v14
  s_lshl_b32 s49, s45, 8
  s_mul_i32 s48, s19, 7340032
  s_add_u32 s49, s49, s48
  v_add_u32 v226, s49, v14
  s_lshl_b32 s49, s50, 2
  s_add_u32 s49, s49, 48
  v_lshrrev_b32 v14, 4, v7
  v_add_u32 v14, s49, v14
  v_and_b32 v15, 3, v14
  v_lshlrev_b32 v15, 2, v15
  v_bfe_u32 v16, v14, 3, 1
  v_lshl_add_u32 v15, v16, 1, v15
  v_and_b32 v16, 15, v7
  v_xor_b32 v16, v16, v15
  v_lshlrev_b32 v14, 12, v14
  v_lshl_add_u32 v14, v16, 4, v14
  s_lshl_b32 s49, s45, 8
  s_mul_i32 s48, s19, 7340032
  s_add_u32 s49, s49, s48
  v_add_u32 v227, s49, v14
  s_sub_u32 s50, s20, 4
  s_lshl_b32 s5, s50, 10
  s_add_u32 s7, s5, 131072
  s_mov_b32 s4, 0
  s_mov_b32 s9, 262144
  s_add_u32 m0, s5, 0
  s_nop 0
  buffer_load_dwordx4 v224, s[28:31], s4 offen lds
  s_add_u32 m0, s5, 4096
  s_nop 0
  buffer_load_dwordx4 v225, s[28:31], s4 offen lds
  s_add_u32 m0, s5, 8192
  s_nop 0
  buffer_load_dwordx4 v226, s[28:31], s4 offen lds
  s_add_u32 m0, s5, 12288
  s_nop 0
  buffer_load_dwordx4 v227, s[28:31], s4 offen lds
  s_add_u32 s4, s4, s9
  s_add_u32 s5, s5, 16384
  s_cmp_ge_u32 s5, s7
  s_cselect_b32 s8, 131072, 0
  s_sub_u32 s5, s5, s8
  s_add_u32 m0, s5, 0
  s_nop 0
  buffer_load_dwordx4 v224, s[28:31], s4 offen lds
  s_add_u32 m0, s5, 4096
  s_nop 0
  buffer_load_dwordx4 v225, s[28:31], s4 offen lds
  s_add_u32 m0, s5, 8192
  s_nop 0
  buffer_load_dwordx4 v226, s[28:31], s4 offen lds
  s_add_u32 m0, s5, 12288
  s_nop 0
  buffer_load_dwordx4 v227, s[28:31], s4 offen lds
  s_add_u32 s4, s4, s9
  s_add_u32 s5, s5, 16384
  s_cmp_ge_u32 s5, s7
  s_cselect_b32 s8, 131072, 0
  s_sub_u32 s5, s5, s8
g2_start_inactive:
g2_start:
  s_lshr_b32 s47, s2, 3
  s_lshr_b32 s44, s47, 2
  s_lshr_b32 s46, s2, 1
  s_and_b32 s46, s46, 3
  s_lshl_b32 s46, s46, 2
  s_and_b32 s47, s47, 3
  s_add_u32 s45, s46, s47
  s_and_b32 s19, s2, 1
  s_add_u32 s24, s82, 16777216
  s_addc_u32 s25, s83, 0
  s_mov_b32 s26, 7340032
  s_mov_b32 s27, 0x00020000
  s_mov_b32 s32, s78
  s_mov_b32 s33, s79
  s_mov_b32 s34, 4194304
  s_mov_b32 s35, 0x00020000
  s_mov_b32 s36, s76
  s_mov_b32 s37, s77
  s_mov_b32 s38, 4096
  s_mov_b32 s39, 0x00020000
  s_add_u32 s40, s82, 8388608
  s_addc_u32 s41, s83, 0
  s_mov_b32 s42, 4194304
  s_mov_b32 s43, 0x00020000
  s_cmp_ge_u32 s20, 4
  s_cbranch_scc1 g2_loader
  s_cmp_eq_u32 s19, 0
  s_cselect_b32 s49, 128, 0
  v_and_b32 v8, 15, v7
  v_lshrrev_b32 v9, 4, v7
  v_lshrrev_b32 v10, 1, v9
  v_lshlrev_b32 v10, 10, v10
  v_and_b32 v11, 1, v9
  v_lshl_add_u32 v10, v11, 9, v10
  v_lshl_add_u32 v10, v8, 4, v10
  v_lshrrev_b32 v12, 2, v8
  v_lshl_add_u32 v13, v9, 3, v12
  v_lshlrev_b32 v12, 2, v12
  v_lshl_add_u32 v12, v11, 1, v12
  v_bfe_u32 v14, v7, 1, 1
  v_xor_b32 v12, v12, v14
  v_lshlrev_b32 v13, 8, v13
  v_lshl_add_u32 v13, v12, 4, v13
  v_and_b32 v14, 1, v7
  v_lshl_add_u32 v16, v14, 3, v13
  v_xor_b32 v16, s49, v16
  v_xor_b32 v17, 32, v16
  v_xor_b32 v18, 64, v16
  v_xor_b32 v19, 96, v16
  v_xor_b32 v20, 128, v16
  v_xor_b32 v21, 160, v16
  v_xor_b32 v22, 192, v16
  v_xor_b32 v23, 224, v16
  s_lshl_b32 s46, s44, 2
  s_add_u32 s46, s46, s20
  s_mul_i32 s48, s46, 229376
  s_mul_i32 s49, s19, 114688
  s_add_u32 s48, s48, s49
  v_add_u32 v1, s48, v10
  s_lshl_b32 s47, s45, 7
  s_lshl_b32 s49, s19, 6
  s_add_u32 s47, s47, s49
  v_add_u32 v11, s47, v8
  v_lshlrev_b32 v12, 1, v11
  buffer_load_ushort v24, v12, s[36:39], 0 offen offset:0
  buffer_load_ushort v25, v12, s[36:39], 0 offen offset:32
  buffer_load_ushort v26, v12, s[36:39], 0 offen offset:64
  buffer_load_ushort v27, v12, s[36:39], 0 offen offset:96
  v_lshlrev_b32 v12, 11, v11
  v_lshl_add_u32 v12, v9, 4, v12
  s_lshl_b32 s48, s46, 6
  v_add_u32 v28, s48, v12
  v_lshlrev_b32 v12, 4, v7
  s_lshl_b32 s47, s20, 12
  s_lshl_b32 s48, s2, 14
  s_add_u32 s48, s48, s47
  v_add_u32 v29, s48, v12
  s_xor_b32 s48, s2, 1
  s_lshl_b32 s48, s48, 14
  s_add_u32 s48, s48, s47
  v_add_u32 v30, s48, v12
  v_mov_b32 v32, 0
  v_mov_b32 v33, 0
  v_mov_b32 v34, 0
  v_mov_b32 v35, 0
  v_mov_b32 v36, 0
  v_mov_b32 v37, 0
  v_mov_b32 v38, 0
  v_mov_b32 v39, 0
  v_mov_b32 v40, 0
  v_mov_b32 v41, 0
  v_mov_b32 v42, 0
  v_mov_b32 v43, 0
  v_mov_b32 v44, 0
  v_mov_b32 v45, 0
  v_mov_b32 v46, 0
  v_mov_b32 v47, 0
  v_mov_b32 v48, 0
  v_mov_b32 v49, 0
  v_mov_b32 v50, 0
  v_mov_b32 v51, 0
  v_mov_b32 v52, 0
  v_mov_b32 v53, 0
  v_mov_b32 v54, 0
  v_mov_b32 v55, 0
  v_mov_b32 v56, 0
  v_mov_b32 v57, 0
  v_mov_b32 v58, 0
  v_mov_b32 v59, 0
  v_mov_b32 v60, 0
  v_mov_b32 v61, 0
  v_mov_b32 v62, 0
  v_mov_b32 v63, 0
  v_mov_b32 v64, 0
  v_mov_b32 v65, 0
  v_mov_b32 v66, 0
  v_mov_b32 v67, 0
  v_mov_b32 v68, 0
  v_mov_b32 v69, 0
  v_mov_b32 v70, 0
  v_mov_b32 v71, 0
  v_mov_b32 v72, 0
  v_mov_b32 v73, 0
  v_mov_b32 v74, 0
  v_mov_b32 v75, 0
  v_mov_b32 v76, 0
  v_mov_b32 v77, 0
  v_mov_b32 v78, 0
  v_mov_b32 v79, 0
  v_mov_b32 v80, 0
  v_mov_b32 v81, 0
  v_mov_b32 v82, 0
  v_mov_b32 v83, 0
  v_mov_b32 v84, 0
  v_mov_b32 v85, 0
  v_mov_b32 v86, 0
  v_mov_b32 v87, 0
  v_mov_b32 v88, 0
  v_mov_b32 v89, 0
  v_mov_b32 v90, 0
  v_mov_b32 v91, 0
  v_mov_b32 v92, 0
  v_mov_b32 v93, 0
  v_mov_b32 v94, 0
  v_mov_b32 v95, 0
  s_waitcnt vmcnt(0)
  s_add_u32 s36, s82, 25165824
  s_addc_u32 s37, s83, 0
  s_mov_b32 s38, 4194304
  s_mov_b32 s39, 0x00020000
  s_mov_b32 s21, 0
  s_mov_b32 s23, 65536
  s_mov_b32 s22, 6
  s_lshl_b32 s18, s44, 1
  s_add_u32 s18, s18, s19
  s_cmp_lg_u32 s20, 0
  s_cbranch_scc1 x4c_w_skip
  s_lshl_b32 s10, s18, 8
  s_add_u32 s10, s10, 12288
  v_mov_b32 v228, s10
  s_mov_b32 s11, 200000
x4c_poll:
  buffer_load_dword v229, v228, s[12:15], 0 offen sc1
  s_waitcnt vmcnt(0)
  v_cmp_le_u32 vcc, 14, v229
  s_nop 1
  s_cmp_eq_u64 vcc, exec
  s_cbranch_scc1 x4c_w_skip
  s_sub_u32 s11, s11, 1
  s_cmp_lg_u32 s11, 0
  s_cbranch_scc1 x4c_poll
x4c_w_skip:
  s_barrier
  buffer_load_dwordx4 v[128:131], v1, s[24:27], s21 offen offset:0 sc1
  buffer_load_dwordx4 v[132:135], v1, s[24:27], s21 offen offset:256 sc1
  buffer_load_dwordx4 v[136:139], v1, s[24:27], s21 offen offset:2048 sc1
  buffer_load_dwordx4 v[140:143], v1, s[24:27], s21 offen offset:2304 sc1
  s_add_u32 s21, s21, 4096
  buffer_load_dwordx4 v[144:147], v1, s[24:27], s21 offen offset:0 sc1
  buffer_load_dwordx4 v[148:151], v1, s[24:27], s21 offen offset:256 sc1
  buffer_load_dwordx4 v[152:155], v1, s[24:27], s21 offen offset:2048 sc1
  buffer_load_dwordx4 v[156:159], v1, s[24:27], s21 offen offset:2304 sc1
  s_add_u32 s21, s21, 4096
  buffer_load_dwordx4 v[160:163], v1, s[24:27], s21 offen offset:0 sc1
  buffer_load_dwordx4 v[164:167], v1, s[24:27], s21 offen offset:256 sc1
  buffer_load_dwordx4 v[168:171], v1, s[24:27], s21 offen offset:2048 sc1
  buffer_load_dwordx4 v[172:175], v1, s[24:27], s21 offen offset:2304 sc1
  s_add_u32 s21, s21, 4096
  buffer_load_dwordx4 v[176:179], v1, s[24:27], s21 offen offset:0 sc1
  buffer_load_dwordx4 v[180:183], v1, s[24:27], s21 offen offset:256 sc1
  s_mov_b32 s47, 0
  buffer_load_dwordx4 v[192:195], v28, s[40:43], s47 offen sc1
  s_mov_b32 s47, 32768
  buffer_load_dwordx4 v[196:199], v28, s[40:43], s47 offen sc1
  s_mov_b32 s47, 65536
  buffer_load_dwordx4 v[200:203], v28, s[40:43], s47 offen sc1
  s_mov_b32 s47, 98304
  buffer_load_dwordx4 v[204:207], v28, s[40:43], s47 offen sc1
  s_barrier
  ds_read_b64_tr_b16 v[96:97], v16 offset:0
  ds_read_b64_tr_b16 v[98:99], v16 offset:1024
  ds_read_b64_tr_b16 v[100:101], v17 offset:0
  ds_read_b64_tr_b16 v[102:103], v17 offset:1024
  ds_read_b64_tr_b16 v[104:105], v18 offset:0
  ds_read_b64_tr_b16 v[106:107], v18 offset:1024
  ds_read_b64_tr_b16 v[108:109], v19 offset:0
  ds_read_b64_tr_b16 v[110:111], v19 offset:1024
  ds_read_b64_tr_b16 v[112:113], v20 offset:0
  ds_read_b64_tr_b16 v[114:115], v20 offset:1024
  ds_read_b64_tr_b16 v[116:117], v21 offset:0
  ds_read_b64_tr_b16 v[118:119], v21 offset:1024
  ds_read_b64_tr_b16 v[120:121], v22 offset:0
  ds_read_b64_tr_b16 v[122:123], v22 offset:1024
g2_loop:
  s_waitcnt vmcnt(12)
  s_waitcnt lgkmcnt(10)
  v_mfma_f32_16x16x32_bf16 v[32:35], v[128:131], v[96:99], v[32:35]
  ds_read_b64_tr_b16 v[124:125], v23 offset:0
  buffer_load_dwordx4 v[184:187], v1, s[24:27], s21 offen offset:2048 sc1
  v_mfma_f32_16x16x32_bf16 v[36:39], v[132:135], v[96:99], v[36:39]
  ds_read_b64_tr_b16 v[126:127], v23 offset:1024
  v_mfma_f32_16x16x32_bf16 v[40:43], v[128:131], v[100:103], v[40:43]
  ds_read_b64_tr_b16 v[96:97], v16 offset:8192
  buffer_load_dwordx4 v[188:191], v1, s[24:27], s21 offen offset:2304 sc1
  v_mfma_f32_16x16x32_bf16 v[44:47], v[132:135], v[100:103], v[44:47]
  ds_read_b64_tr_b16 v[98:99], v16 offset:9216
  s_waitcnt lgkmcnt(10)
  v_mfma_f32_16x16x32_bf16 v[48:51], v[128:131], v[104:107], v[48:51]
  ds_read_b64_tr_b16 v[100:101], v17 offset:8192
  s_add_u32 s21, s21, 4096
  v_mfma_f32_16x16x32_bf16 v[52:55], v[132:135], v[104:107], v[52:55]
  ds_read_b64_tr_b16 v[102:103], v17 offset:9216
  v_mfma_f32_16x16x32_bf16 v[56:59], v[128:131], v[108:111], v[56:59]
  ds_read_b64_tr_b16 v[104:105], v18 offset:8192
  v_mfma_f32_16x16x32_bf16 v[60:63], v[132:135], v[108:111], v[60:63]
  ds_read_b64_tr_b16 v[106:107], v18 offset:9216
  s_waitcnt lgkmcnt(10)
  v_mfma_f32_16x16x32_bf16 v[64:67], v[128:131], v[112:115], v[64:67]
  ds_read_b64_tr_b16 v[108:109], v19 offset:8192
  v_mfma_f32_16x16x32_bf16 v[68:71], v[132:135], v[112:115], v[68:71]
  ds_read_b64_tr_b16 v[110:111], v19 offset:9216
  v_mfma_f32_16x16x32_bf16 v[72:75], v[128:131], v[116:119], v[72:75]
  ds_read_b64_tr_b16 v[112:113], v20 offset:8192
  v_mfma_f32_16x16x32_bf16 v[76:79], v[132:135], v[116:119], v[76:79]
  ds_read_b64_tr_b16 v[114:115], v20 offset:9216
  s_waitcnt lgkmcnt(10)
  v_mfma_f32_16x16x32_bf16 v[80:83], v[128:131], v[120:123], v[80:83]
  ds_read_b64_tr_b16 v[116:117], v21 offset:8192
  v_mfma_f32_16x16x32_bf16 v[84:87], v[132:135], v[120:123], v[84:87]
  ds_read_b64_tr_b16 v[118:119], v21 offset:9216
  v_mfma_f32_16x16x32_bf16 v[88:91], v[128:131], v[124:127], v[88:91]
  ds_read_b64_tr_b16 v[120:121], v22 offset:8192
  s_waitcnt vmcnt(12)
  v_mfma_f32_16x16x32_bf16 v[92:95], v[132:135], v[124:127], v[92:95]
  ds_read_b64_tr_b16 v[122:123], v22 offset:9216
  s_waitcnt lgkmcnt(10)
  v_mfma_f32_16x16x32_bf16 v[32:35], v[136:139], v[96:99], v[32:35]
  ds_read_b64_tr_b16 v[124:125], v23 offset:8192
  buffer_load_dwordx4 v[128:131], v1, s[24:27], s21 offen offset:0 sc1
  v_mfma_f32_16x16x32_bf16 v[36:39], v[140:143], v[96:99], v[36:39]
  ds_read_b64_tr_b16 v[126:127], v23 offset:9216
  s_barrier
  v_mfma_f32_16x16x32_bf16 v[40:43], v[136:139], v[100:103], v[40:43]
  ds_read_b64_tr_b16 v[96:97], v16 offset:16384
  buffer_load_dwordx4 v[132:135], v1, s[24:27], s21 offen offset:256 sc1
  v_mfma_f32_16x16x32_bf16 v[44:47], v[140:143], v[100:103], v[44:47]
  ds_read_b64_tr_b16 v[98:99], v16 offset:17408
  s_waitcnt lgkmcnt(10)
  v_mfma_f32_16x16x32_bf16 v[48:51], v[136:139], v[104:107], v[48:51]
  ds_read_b64_tr_b16 v[100:101], v17 offset:16384
  v_mfma_f32_16x16x32_bf16 v[52:55], v[140:143], v[104:107], v[52:55]
  ds_read_b64_tr_b16 v[102:103], v17 offset:17408
  v_mfma_f32_16x16x32_bf16 v[56:59], v[136:139], v[108:111], v[56:59]
  ds_read_b64_tr_b16 v[104:105], v18 offset:16384
  v_mfma_f32_16x16x32_bf16 v[60:63], v[140:143], v[108:111], v[60:63]
  ds_read_b64_tr_b16 v[106:107], v18 offset:17408
  s_waitcnt lgkmcnt(10)
  v_mfma_f32_16x16x32_bf16 v[64:67], v[136:139], v[112:115], v[64:67]
  ds_read_b64_tr_b16 v[108:109], v19 offset:16384
  v_mfma_f32_16x16x32_bf16 v[68:71], v[140:143], v[112:115], v[68:71]
  ds_read_b64_tr_b16 v[110:111], v19 offset:17408
  v_mfma_f32_16x16x32_bf16 v[72:75], v[136:139], v[116:119], v[72:75]
  ds_read_b64_tr_b16 v[112:113], v20 offset:16384
  v_mfma_f32_16x16x32_bf16 v[76:79], v[140:143], v[116:119], v[76:79]
  ds_read_b64_tr_b16 v[114:115], v20 offset:17408
  s_waitcnt lgkmcnt(10)
  v_mfma_f32_16x16x32_bf16 v[80:83], v[136:139], v[120:123], v[80:83]
  ds_read_b64_tr_b16 v[116:117], v21 offset:16384
  v_mfma_f32_16x16x32_bf16 v[84:87], v[140:143], v[120:123], v[84:87]
  ds_read_b64_tr_b16 v[118:119], v21 offset:17408
  v_mfma_f32_16x16x32_bf16 v[88:91], v[136:139], v[124:127], v[88:91]
  ds_read_b64_tr_b16 v[120:121], v22 offset:16384
  s_waitcnt vmcnt(12)
  v_mfma_f32_16x16x32_bf16 v[92:95], v[140:143], v[124:127], v[92:95]
  ds_read_b64_tr_b16 v[122:123], v22 offset:17408
  s_waitcnt lgkmcnt(10)
  v_mfma_f32_16x16x32_bf16 v[32:35], v[144:147], v[96:99], v[32:35]
  ds_read_b64_tr_b16 v[124:125], v23 offset:16384
  buffer_load_dwordx4 v[136:139], v1, s[24:27], s21 offen offset:2048 sc1
  v_mfma_f32_16x16x32_bf16 v[36:39], v[148:151], v[96:99], v[36:39]
  ds_read_b64_tr_b16 v[126:127], v23 offset:17408
  v_mfma_f32_16x16x32_bf16 v[40:43], v[144:147], v[100:103], v[40:43]
  ds_read_b64_tr_b16 v[96:97], v16 offset:24576
  buffer_load_dwordx4 v[140:143], v1, s[24:27], s21 offen offset:2304 sc1
  v_mfma_f32_16x16x32_bf16 v[44:47], v[148:151], v[100:103], v[44:47]
  ds_read_b64_tr_b16 v[98:99], v16 offset:25600
  s_waitcnt lgkmcnt(10)
  v_mfma_f32_16x16x32_bf16 v[48:51], v[144:147], v[104:107], v[48:51]
  ds_read_b64_tr_b16 v[100:101], v17 offset:24576
  s_add_u32 s21, s21, 4096
  v_mfma_f32_16x16x32_bf16 v[52:55], v[148:151], v[104:107], v[52:55]
  ds_read_b64_tr_b16 v[102:103], v17 offset:25600
  v_mfma_f32_16x16x32_bf16 v[56:59], v[144:147], v[108:111], v[56:59]
  ds_read_b64_tr_b16 v[104:105], v18 offset:24576
  v_mfma_f32_16x16x32_bf16 v[60:63], v[148:151], v[108:111], v[60:63]
  ds_read_b64_tr_b16 v[106:107], v18 offset:25600
  s_waitcnt lgkmcnt(10)
  v_mfma_f32_16x16x32_bf16 v[64:67], v[144:147], v[112:115], v[64:67]
  ds_read_b64_tr_b16 v[108:109], v19 offset:24576
  v_mfma_f32_16x16x32_bf16 v[68:71], v[148:151], v[112:115], v[68:71]
  ds_read_b64_tr_b16 v[110:111], v19 offset:25600
  v_mfma_f32_16x16x32_bf16 v[72:75], v[144:147], v[116:119], v[72:75]
  ds_read_b64_tr_b16 v[112:113], v20 offset:24576
  v_mfma_f32_16x16x32_bf16 v[76:79], v[148:151], v[116:119], v[76:79]
  ds_read_b64_tr_b16 v[114:115], v20 offset:25600
  s_waitcnt lgkmcnt(10)
  v_mfma_f32_16x16x32_bf16 v[80:83], v[144:147], v[120:123], v[80:83]
  ds_read_b64_tr_b16 v[116:117], v21 offset:24576
  v_mfma_f32_16x16x32_bf16 v[84:87], v[148:151], v[120:123], v[84:87]
  ds_read_b64_tr_b16 v[118:119], v21 offset:25600
  v_mfma_f32_16x16x32_bf16 v[88:91], v[144:147], v[124:127], v[88:91]
  ds_read_b64_tr_b16 v[120:121], v22 offset:24576
  s_waitcnt vmcnt(12)
  v_mfma_f32_16x16x32_bf16 v[92:95], v[148:151], v[124:127], v[92:95]
  ds_read_b64_tr_b16 v[122:123], v22 offset:25600
  s_waitcnt lgkmcnt(10)
  v_mfma_f32_16x16x32_bf16 v[32:35], v[152:155], v[96:99], v[32:35]
  ds_read_b64_tr_b16 v[124:125], v23 offset:24576
  buffer_load_dwordx4 v[144:147], v1, s[24:27], s21 offen offset:0 sc1
  v_mfma_f32_16x16x32_bf16 v[36:39], v[156:159], v[96:99], v[36:39]
  ds_read_b64_tr_b16 v[126:127], v23 offset:25600
  s_barrier
  v_mfma_f32_16x16x32_bf16 v[40:43], v[152:155], v[100:103], v[40:43]
  ds_read_b64_tr_b16 v[96:97], v16 offset:32768
  buffer_load_dwordx4 v[148:151], v1, s[24:27], s21 offen offset:256 sc1
  v_mfma_f32_16x16x32_bf16 v[44:47], v[156:159], v[100:103], v[44:47]
  ds_read_b64_tr_b16 v[98:99], v16 offset:33792
  s_waitcnt lgkmcnt(10)
  v_mfma_f32_16x16x32_bf16 v[48:51], v[152:155], v[104:107], v[48:51]
  ds_read_b64_tr_b16 v[100:101], v17 offset:32768
  v_mfma_f32_16x16x32_bf16 v[52:55], v[156:159], v[104:107], v[52:55]
  ds_read_b64_tr_b16 v[102:103], v17 offset:33792
  v_mfma_f32_16x16x32_bf16 v[56:59], v[152:155], v[108:111], v[56:59]
  ds_read_b64_tr_b16 v[104:105], v18 offset:32768
  v_mfma_f32_16x16x32_bf16 v[60:63], v[156:159], v[108:111], v[60:63]
  ds_read_b64_tr_b16 v[106:107], v18 offset:33792
  s_waitcnt lgkmcnt(10)
  v_mfma_f32_16x16x32_bf16 v[64:67], v[152:155], v[112:115], v[64:67]
  ds_read_b64_tr_b16 v[108:109], v19 offset:32768
  v_mfma_f32_16x16x32_bf16 v[68:71], v[156:159], v[112:115], v[68:71]
  ds_read_b64_tr_b16 v[110:111], v19 offset:33792
  v_mfma_f32_16x16x32_bf16 v[72:75], v[152:155], v[116:119], v[72:75]
  ds_read_b64_tr_b16 v[112:113], v20 offset:32768
  v_mfma_f32_16x16x32_bf16 v[76:79], v[156:159], v[116:119], v[76:79]
  ds_read_b64_tr_b16 v[114:115], v20 offset:33792
  s_waitcnt lgkmcnt(10)
  v_mfma_f32_16x16x32_bf16 v[80:83], v[152:155], v[120:123], v[80:83]
  ds_read_b64_tr_b16 v[116:117], v21 offset:32768
  v_mfma_f32_16x16x32_bf16 v[84:87], v[156:159], v[120:123], v[84:87]
  ds_read_b64_tr_b16 v[118:119], v21 offset:33792
  v_mfma_f32_16x16x32_bf16 v[88:91], v[152:155], v[124:127], v[88:91]
  ds_read_b64_tr_b16 v[120:121], v22 offset:32768
  s_waitcnt vmcnt(12)
  v_mfma_f32_16x16x32_bf16 v[92:95], v[156:159], v[124:127], v[92:95]
  ds_read_b64_tr_b16 v[122:123], v22 offset:33792
  s_waitcnt lgkmcnt(10)
  v_mfma_f32_16x16x32_bf16 v[32:35], v[160:163], v[96:99], v[32:35]
  ds_read_b64_tr_b16 v[124:125], v23 offset:32768
  buffer_load_dwordx4 v[152:155], v1, s[24:27], s21 offen offset:2048 sc1
  v_mfma_f32_16x16x32_bf16 v[36:39], v[164:167], v[96:99], v[36:39]
  ds_read_b64_tr_b16 v[126:127], v23 offset:33792
  v_mfma_f32_16x16x32_bf16 v[40:43], v[160:163], v[100:103], v[40:43]
  ds_read_b64_tr_b16 v[96:97], v16 offset:40960
  buffer_load_dwordx4 v[156:159], v1, s[24:27], s21 offen offset:2304 sc1
  v_mfma_f32_16x16x32_bf16 v[44:47], v[164:167], v[100:103], v[44:47]
  ds_read_b64_tr_b16 v[98:99], v16 offset:41984
  s_waitcnt lgkmcnt(10)
  v_mfma_f32_16x16x32_bf16 v[48:51], v[160:163], v[104:107], v[48:51]
  ds_read_b64_tr_b16 v[100:101], v17 offset:40960
  s_add_u32 s21, s21, 4096
  v_mfma_f32_16x16x32_bf16 v[52:55], v[164:167], v[104:107], v[52:55]
  ds_read_b64_tr_b16 v[102:103], v17 offset:41984
  v_mfma_f32_16x16x32_bf16 v[56:59], v[160:163], v[108:111], v[56:59]
  ds_read_b64_tr_b16 v[104:105], v18 offset:40960
  v_mfma_f32_16x16x32_bf16 v[60:63], v[164:167], v[108:111], v[60:63]
  ds_read_b64_tr_b16 v[106:107], v18 offset:41984
  s_waitcnt lgkmcnt(10)
  v_mfma_f32_16x16x32_bf16 v[64:67], v[160:163], v[112:115], v[64:67]
  ds_read_b64_tr_b16 v[108:109], v19 offset:40960
  v_mfma_f32_16x16x32_bf16 v[68:71], v[164:167], v[112:115], v[68:71]
  ds_read_b64_tr_b16 v[110:111], v19 offset:41984
  v_mfma_f32_16x16x32_bf16 v[72:75], v[160:163], v[116:119], v[72:75]
  ds_read_b64_tr_b16 v[112:113], v20 offset:40960
  v_mfma_f32_16x16x32_bf16 v[76:79], v[164:167], v[116:119], v[76:79]
  ds_read_b64_tr_b16 v[114:115], v20 offset:41984
  s_waitcnt lgkmcnt(10)
  v_mfma_f32_16x16x32_bf16 v[80:83], v[160:163], v[120:123], v[80:83]
  ds_read_b64_tr_b16 v[116:117], v21 offset:40960
  v_mfma_f32_16x16x32_bf16 v[84:87], v[164:167], v[120:123], v[84:87]
  ds_read_b64_tr_b16 v[118:119], v21 offset:41984
  v_mfma_f32_16x16x32_bf16 v[88:91], v[160:163], v[124:127], v[88:91]
  ds_read_b64_tr_b16 v[120:121], v22 offset:40960
  s_waitcnt vmcnt(12)
  v_mfma_f32_16x16x32_bf16 v[92:95], v[164:167], v[124:127], v[92:95]
  ds_read_b64_tr_b16 v[122:123], v22 offset:41984
  s_waitcnt lgkmcnt(10)
  v_mfma_f32_16x16x32_bf16 v[32:35], v[168:171], v[96:99], v[32:35]
  ds_read_b64_tr_b16 v[124:125], v23 offset:40960
  buffer_load_dwordx4 v[160:163], v1, s[24:27], s21 offen offset:0 sc1
  v_mfma_f32_16x16x32_bf16 v[36:39], v[172:175], v[96:99], v[36:39]
  ds_read_b64_tr_b16 v[126:127], v23 offset:41984
  s_barrier
  v_mfma_f32_16x16x32_bf16 v[40:43], v[168:171], v[100:103], v[40:43]
  ds_read_b64_tr_b16 v[96:97], v16 offset:49152
  buffer_load_dwordx4 v[164:167], v1, s[24:27], s21 offen offset:256 sc1
  v_mfma_f32_16x16x32_bf16 v[44:47], v[172:175], v[100:103], v[44:47]
  ds_read_b64_tr_b16 v[98:99], v16 offset:50176
  s_waitcnt lgkmcnt(10)
  v_mfma_f32_16x16x32_bf16 v[48:51], v[168:171], v[104:107], v[48:51]
  ds_read_b64_tr_b16 v[100:101], v17 offset:49152
  v_mfma_f32_16x16x32_bf16 v[52:55], v[172:175], v[104:107], v[52:55]
  ds_read_b64_tr_b16 v[102:103], v17 offset:50176
  v_mfma_f32_16x16x32_bf16 v[56:59], v[168:171], v[108:111], v[56:59]
  ds_read_b64_tr_b16 v[104:105], v18 offset:49152
  v_mfma_f32_16x16x32_bf16 v[60:63], v[172:175], v[108:111], v[60:63]
  ds_read_b64_tr_b16 v[106:107], v18 offset:50176
  s_waitcnt lgkmcnt(10)
  v_mfma_f32_16x16x32_bf16 v[64:67], v[168:171], v[112:115], v[64:67]
  ds_read_b64_tr_b16 v[108:109], v19 offset:49152
  v_mfma_f32_16x16x32_bf16 v[68:71], v[172:175], v[112:115], v[68:71]
  ds_read_b64_tr_b16 v[110:111], v19 offset:50176
  v_mfma_f32_16x16x32_bf16 v[72:75], v[168:171], v[116:119], v[72:75]
  ds_read_b64_tr_b16 v[112:113], v20 offset:49152
  v_mfma_f32_16x16x32_bf16 v[76:79], v[172:175], v[116:119], v[76:79]
  ds_read_b64_tr_b16 v[114:115], v20 offset:50176
  s_waitcnt lgkmcnt(10)
  v_mfma_f32_16x16x32_bf16 v[80:83], v[168:171], v[120:123], v[80:83]
  ds_read_b64_tr_b16 v[116:117], v21 offset:49152
  v_mfma_f32_16x16x32_bf16 v[84:87], v[172:175], v[120:123], v[84:87]
  ds_read_b64_tr_b16 v[118:119], v21 offset:50176
  v_mfma_f32_16x16x32_bf16 v[88:91], v[168:171], v[124:127], v[88:91]
  ds_read_b64_tr_b16 v[120:121], v22 offset:49152
  s_waitcnt vmcnt(12)
  v_mfma_f32_16x16x32_bf16 v[92:95], v[172:175], v[124:127], v[92:95]
  ds_read_b64_tr_b16 v[122:123], v22 offset:50176
  s_waitcnt lgkmcnt(10)
  v_mfma_f32_16x16x32_bf16 v[32:35], v[176:179], v[96:99], v[32:35]
  ds_read_b64_tr_b16 v[124:125], v23 offset:49152
  buffer_load_dwordx4 v[168:171], v1, s[24:27], s21 offen offset:2048 sc1
  v_mfma_f32_16x16x32_bf16 v[36:39], v[180:183], v[96:99], v[36:39]
  ds_read_b64_tr_b16 v[126:127], v23 offset:50176
  v_mfma_f32_16x16x32_bf16 v[40:43], v[176:179], v[100:103], v[40:43]
  ds_read_b64_tr_b16 v[96:97], v16 offset:57344
  buffer_load_dwordx4 v[172:175], v1, s[24:27], s21 offen offset:2304 sc1
  v_mfma_f32_16x16x32_bf16 v[44:47], v[180:183], v[100:103], v[44:47]
  ds_read_b64_tr_b16 v[98:99], v16 offset:58368
  s_waitcnt lgkmcnt(10)
  v_mfma_f32_16x16x32_bf16 v[48:51], v[176:179], v[104:107], v[48:51]
  ds_read_b64_tr_b16 v[100:101], v17 offset:57344
  s_add_u32 s21, s21, 4096
  v_mfma_f32_16x16x32_bf16 v[52:55], v[180:183], v[104:107], v[52:55]
  ds_read_b64_tr_b16 v[102:103], v17 offset:58368
  v_mfma_f32_16x16x32_bf16 v[56:59], v[176:179], v[108:111], v[56:59]
  ds_read_b64_tr_b16 v[104:105], v18 offset:57344
  v_mfma_f32_16x16x32_bf16 v[60:63], v[180:183], v[108:111], v[60:63]
  ds_read_b64_tr_b16 v[106:107], v18 offset:58368
  s_waitcnt lgkmcnt(10)
  v_mfma_f32_16x16x32_bf16 v[64:67], v[176:179], v[112:115], v[64:67]
  ds_read_b64_tr_b16 v[108:109], v19 offset:57344
  v_mfma_f32_16x16x32_bf16 v[68:71], v[180:183], v[112:115], v[68:71]
  ds_read_b64_tr_b16 v[110:111], v19 offset:58368
  v_mfma_f32_16x16x32_bf16 v[72:75], v[176:179], v[116:119], v[72:75]
  ds_read_b64_tr_b16 v[112:113], v20 offset:57344
  v_mfma_f32_16x16x32_bf16 v[76:79], v[180:183], v[116:119], v[76:79]
  ds_read_b64_tr_b16 v[114:115], v20 offset:58368
  s_waitcnt lgkmcnt(10)
  v_mfma_f32_16x16x32_bf16 v[80:83], v[176:179], v[120:123], v[80:83]
  ds_read_b64_tr_b16 v[116:117], v21 offset:57344
  v_mfma_f32_16x16x32_bf16 v[84:87], v[180:183], v[120:123], v[84:87]
  ds_read_b64_tr_b16 v[118:119], v21 offset:58368
  v_mfma_f32_16x16x32_bf16 v[88:91], v[176:179], v[124:127], v[88:91]
  ds_read_b64_tr_b16 v[120:121], v22 offset:57344
  s_waitcnt vmcnt(12)
  v_mfma_f32_16x16x32_bf16 v[92:95], v[180:183], v[124:127], v[92:95]
  ds_read_b64_tr_b16 v[122:123], v22 offset:58368
  s_waitcnt lgkmcnt(10)
  v_mfma_f32_16x16x32_bf16 v[32:35], v[184:187], v[96:99], v[32:35]
  ds_read_b64_tr_b16 v[124:125], v23 offset:57344
  buffer_load_dwordx4 v[176:179], v1, s[24:27], s21 offen offset:0 sc1
  v_mfma_f32_16x16x32_bf16 v[36:39], v[188:191], v[96:99], v[36:39]
  ds_read_b64_tr_b16 v[126:127], v23 offset:58368
  s_barrier
  v_add_u32 v16, s23, v16
  v_mfma_f32_16x16x32_bf16 v[40:43], v[184:187], v[100:103], v[40:43]
  ds_read_b64_tr_b16 v[96:97], v16 offset:0
  buffer_load_dwordx4 v[180:183], v1, s[24:27], s21 offen offset:256 sc1
  v_mfma_f32_16x16x32_bf16 v[44:47], v[188:191], v[100:103], v[44:47]
  ds_read_b64_tr_b16 v[98:99], v16 offset:1024
  s_waitcnt lgkmcnt(10)
  v_add_u32 v17, s23, v17
  v_mfma_f32_16x16x32_bf16 v[48:51], v[184:187], v[104:107], v[48:51]
  ds_read_b64_tr_b16 v[100:101], v17 offset:0
  v_mfma_f32_16x16x32_bf16 v[52:55], v[188:191], v[104:107], v[52:55]
  ds_read_b64_tr_b16 v[102:103], v17 offset:1024
  v_add_u32 v18, s23, v18
  v_mfma_f32_16x16x32_bf16 v[56:59], v[184:187], v[108:111], v[56:59]
  ds_read_b64_tr_b16 v[104:105], v18 offset:0
  v_mfma_f32_16x16x32_bf16 v[60:63], v[188:191], v[108:111], v[60:63]
  ds_read_b64_tr_b16 v[106:107], v18 offset:1024
  s_waitcnt lgkmcnt(10)
  v_add_u32 v19, s23, v19
  v_mfma_f32_16x16x32_bf16 v[64:67], v[184:187], v[112:115], v[64:67]
  ds_read_b64_tr_b16 v[108:109], v19 offset:0
  v_mfma_f32_16x16x32_bf16 v[68:71], v[188:191], v[112:115], v[68:71]
  ds_read_b64_tr_b16 v[110:111], v19 offset:1024
  v_add_u32 v20, s23, v20
  v_mfma_f32_16x16x32_bf16 v[72:75], v[184:187], v[116:119], v[72:75]
  ds_read_b64_tr_b16 v[112:113], v20 offset:0
  v_mfma_f32_16x16x32_bf16 v[76:79], v[188:191], v[116:119], v[76:79]
  ds_read_b64_tr_b16 v[114:115], v20 offset:1024
  s_waitcnt lgkmcnt(10)
  v_add_u32 v21, s23, v21
  v_mfma_f32_16x16x32_bf16 v[80:83], v[184:187], v[120:123], v[80:83]
  ds_read_b64_tr_b16 v[116:117], v21 offset:0
  v_mfma_f32_16x16x32_bf16 v[84:87], v[188:191], v[120:123], v[84:87]
  ds_read_b64_tr_b16 v[118:119], v21 offset:1024
  v_add_u32 v22, s23, v22
  v_mfma_f32_16x16x32_bf16 v[88:91], v[184:187], v[124:127], v[88:91]
  ds_read_b64_tr_b16 v[120:121], v22 offset:0
  v_mfma_f32_16x16x32_bf16 v[92:95], v[188:191], v[124:127], v[92:95]
  ds_read_b64_tr_b16 v[122:123], v22 offset:1024
  v_add_u32 v23, s23, v23
  s_sub_u32 s23, 0, s23
  s_sub_u32 s22, s22, 1
  s_cmp_lg_u32 s22, 0
  s_cbranch_scc1 g2_loop
  s_waitcnt vmcnt(12)
  s_waitcnt lgkmcnt(10)
  v_mfma_f32_16x16x32_bf16 v[32:35], v[128:131], v[96:99], v[32:35]
  ds_read_b64_tr_b16 v[124:125], v23 offset:0
  v_mfma_f32_16x16x32_bf16 v[36:39], v[132:135], v[96:99], v[36:39]
  ds_read_b64_tr_b16 v[126:127], v23 offset:1024
  buffer_load_dwordx4 v[184:187], v1, s[24:27], s21 offen offset:2048 sc1
  buffer_load_dwordx4 v[188:191], v1, s[24:27], s21 offen offset:2304 sc1
  s_add_u32 s21, s21, 4096
  v_mfma_f32_16x16x32_bf16 v[40:43], v[128:131], v[100:103], v[40:43]
  ds_read_b64_tr_b16 v[96:97], v16 offset:8192
  v_mfma_f32_16x16x32_bf16 v[44:47], v[132:135], v[100:103], v[44:47]
  ds_read_b64_tr_b16 v[98:99], v16 offset:9216
  s_waitcnt lgkmcnt(10)
  v_mfma_f32_16x16x32_bf16 v[48:51], v[128:131], v[104:107], v[48:51]
  ds_read_b64_tr_b16 v[100:101], v17 offset:8192
  v_mfma_f32_16x16x32_bf16 v[52:55], v[132:135], v[104:107], v[52:55]
  ds_read_b64_tr_b16 v[102:103], v17 offset:9216
  v_mfma_f32_16x16x32_bf16 v[56:59], v[128:131], v[108:111], v[56:59]
  ds_read_b64_tr_b16 v[104:105], v18 offset:8192
  v_mfma_f32_16x16x32_bf16 v[60:63], v[132:135], v[108:111], v[60:63]
  ds_read_b64_tr_b16 v[106:107], v18 offset:9216
  s_waitcnt lgkmcnt(10)
  v_mfma_f32_16x16x32_bf16 v[64:67], v[128:131], v[112:115], v[64:67]
  ds_read_b64_tr_b16 v[108:109], v19 offset:8192
  v_mfma_f32_16x16x32_bf16 v[68:71], v[132:135], v[112:115], v[68:71]
  ds_read_b64_tr_b16 v[110:111], v19 offset:9216
  v_mfma_f32_16x16x32_bf16 v[72:75], v[128:131], v[116:119], v[72:75]
  ds_read_b64_tr_b16 v[112:113], v20 offset:8192
  v_mfma_f32_16x16x32_bf16 v[76:79], v[132:135], v[116:119], v[76:79]
  ds_read_b64_tr_b16 v[114:115], v20 offset:9216
  s_waitcnt lgkmcnt(10)
  v_mfma_f32_16x16x32_bf16 v[80:83], v[128:131], v[120:123], v[80:83]
  ds_read_b64_tr_b16 v[116:117], v21 offset:8192
  v_mfma_f32_16x16x32_bf16 v[84:87], v[132:135], v[120:123], v[84:87]
  ds_read_b64_tr_b16 v[118:119], v21 offset:9216
  v_mfma_f32_16x16x32_bf16 v[88:91], v[128:131], v[124:127], v[88:91]
  ds_read_b64_tr_b16 v[120:121], v22 offset:8192
  v_mfma_f32_16x16x32_bf16 v[92:95], v[132:135], v[124:127], v[92:95]
  ds_read_b64_tr_b16 v[122:123], v22 offset:9216
  s_waitcnt vmcnt(12)
  s_waitcnt lgkmcnt(10)
  v_mfma_f32_16x16x32_bf16 v[32:35], v[136:139], v[96:99], v[32:35]
  ds_read_b64_tr_b16 v[124:125], v23 offset:8192
  v_mfma_f32_16x16x32_bf16 v[36:39], v[140:143], v[96:99], v[36:39]
  ds_read_b64_tr_b16 v[126:127], v23 offset:9216
  s_barrier
  s_barrier
  v_mfma_f32_16x16x32_bf16 v[40:43], v[136:139], v[100:103], v[40:43]
  ds_read_b64_tr_b16 v[96:97], v16 offset:16384
  v_mfma_f32_16x16x32_bf16 v[44:47], v[140:143], v[100:103], v[44:47]
  ds_read_b64_tr_b16 v[98:99], v16 offset:17408
  s_waitcnt lgkmcnt(10)
  v_mfma_f32_16x16x32_bf16 v[48:51], v[136:139], v[104:107], v[48:51]
  ds_read_b64_tr_b16 v[100:101], v16 offset:24576
  v_mfma_f32_16x16x32_bf16 v[52:55], v[140:143], v[104:107], v[52:55]
  ds_read_b64_tr_b16 v[102:103], v16 offset:25600
  v_mfma_f32_16x16x32_bf16 v[56:59], v[136:139], v[108:111], v[56:59]
  ds_read_b64_tr_b16 v[104:105], v16 offset:32768
  v_mfma_f32_16x16x32_bf16 v[60:63], v[140:143], v[108:111], v[60:63]
  ds_read_b64_tr_b16 v[106:107], v16 offset:33792
  s_waitcnt lgkmcnt(10)
  v_mfma_f32_16x16x32_bf16 v[64:67], v[136:139], v[112:115], v[64:67]
  ds_read_b64_tr_b16 v[108:109], v16 offset:40960
  v_mfma_f32_16x16x32_bf16 v[68:71], v[140:143], v[112:115], v[68:71]
  ds_read_b64_tr_b16 v[110:111], v16 offset:41984
  s_barrier
  v_mfma_f32_16x16x32_bf16 v[72:75], v[136:139], v[116:119], v[72:75]
  ds_read_b64_tr_b16 v[112:113], v16 offset:49152
  v_mfma_f32_16x16x32_bf16 v[76:79], v[140:143], v[116:119], v[76:79]
  ds_read_b64_tr_b16 v[114:115], v16 offset:50176
  s_waitcnt lgkmcnt(10)
  v_mfma_f32_16x16x32_bf16 v[80:83], v[136:139], v[120:123], v[80:83]
  ds_read_b64_tr_b16 v[116:117], v16 offset:57344
  v_mfma_f32_16x16x32_bf16 v[84:87], v[140:143], v[120:123], v[84:87]
  ds_read_b64_tr_b16 v[118:119], v16 offset:58368
  v_mfma_f32_16x16x32_bf16 v[88:91], v[136:139], v[124:127], v[88:91]
  ds_read_b64_tr_b16 v[120:121], v17 offset:16384
  v_mfma_f32_16x16x32_bf16 v[92:95], v[140:143], v[124:127], v[92:95]
  ds_read_b64_tr_b16 v[122:123], v17 offset:17408
  s_waitcnt vmcnt(10)
  s_waitcnt lgkmcnt(10)
  v_mfma_f32_16x16x32_bf16 v[32:35], v[144:147], v[96:99], v[32:35]
  ds_read_b64_tr_b16 v[124:125], v17 offset:24576
  v_mfma_f32_16x16x32_bf16 v[36:39], v[148:151], v[96:99], v[36:39]
  ds_read_b64_tr_b16 v[126:127], v17 offset:25600
  s_waitcnt vmcnt(8)
  v_mfma_f32_16x16x32_bf16 v[32:35], v[152:155], v[100:103], v[32:35]
  ds_read_b64_tr_b16 v[96:97], v17 offset:32768
  v_mfma_f32_16x16x32_bf16 v[36:39], v[156:159], v[100:103], v[36:39]
  ds_read_b64_tr_b16 v[98:99], v17 offset:33792
  s_waitcnt vmcnt(6)
  s_waitcnt lgkmcnt(10)
  v_mfma_f32_16x16x32_bf16 v[32:35], v[160:163], v[104:107], v[32:35]
  ds_read_b64_tr_b16 v[100:101], v17 offset:40960
  v_mfma_f32_16x16x32_bf16 v[36:39], v[164:167], v[104:107], v[36:39]
  ds_read_b64_tr_b16 v[102:103], v17 offset:41984
  s_waitcnt vmcnt(4)
  v_mfma_f32_16x16x32_bf16 v[32:35], v[168:171], v[108:111], v[32:35]
  ds_read_b64_tr_b16 v[104:105], v17 offset:49152
  v_mfma_f32_16x16x32_bf16 v[36:39], v[172:175], v[108:111], v[36:39]
  ds_read_b64_tr_b16 v[106:107], v17 offset:50176
  s_waitcnt vmcnt(2)
  s_waitcnt lgkmcnt(10)
  v_mfma_f32_16x16x32_bf16 v[32:35], v[176:179], v[112:115], v[32:35]
  ds_read_b64_tr_b16 v[108:109], v17 offset:57344
  v_mfma_f32_16x16x32_bf16 v[36:39], v[180:183], v[112:115], v[36:39]
  ds_read_b64_tr_b16 v[110:111], v17 offset:58368
  s_waitcnt vmcnt(0)
  v_mfma_f32_16x16x32_bf16 v[32:35], v[184:187], v[116:119], v[32:35]
  ds_read_b64_tr_b16 v[112:113], v18 offset:16384
  v_mfma_f32_16x16x32_bf16 v[36:39], v[188:191], v[116:119], v[36:39]
  ds_read_b64_tr_b16 v[114:115], v18 offset:17408
  s_waitcnt lgkmcnt(10)
  v_mfma_f32_16x16x32_bf16 v[40:43], v[144:147], v[120:123], v[40:43]
  ds_read_b64_tr_b16 v[116:117], v18 offset:24576
  v_mfma_f32_16x16x32_bf16 v[44:47], v[148:151], v[120:123], v[44:47]
  ds_read_b64_tr_b16 v[118:119], v18 offset:25600
  v_mfma_f32_16x16x32_bf16 v[40:43], v[152:155], v[124:127], v[40:43]
  ds_read_b64_tr_b16 v[120:121], v18 offset:32768
  v_cvt_pk_bf16_f32 v208, v32, v33
  v_mfma_f32_16x16x32_bf16 v[44:47], v[156:159], v[124:127], v[44:47]
  ds_read_b64_tr_b16 v[122:123], v18 offset:33792
  v_cvt_pk_bf16_f32 v209, v34, v35
  s_waitcnt lgkmcnt(10)
  v_mfma_f32_16x16x32_bf16 v[40:43], v[160:163], v[96:99], v[40:43]
  ds_read_b64_tr_b16 v[124:125], v18 offset:40960
  v_cvt_pk_bf16_f32 v210, v36, v37
  v_mfma_f32_16x16x32_bf16 v[44:47], v[164:167], v[96:99], v[44:47]
  ds_read_b64_tr_b16 v[126:127], v18 offset:41984
  v_cvt_pk_bf16_f32 v211, v38, v39
  v_mfma_f32_16x16x32_bf16 v[40:43], v[168:171], v[100:103], v[40:43]
  ds_read_b64_tr_b16 v[96:97], v18 offset:49152
  v_min_u32 v208, 0xfffffffe, v208
  v_mfma_f32_16x16x32_bf16 v[44:47], v[172:175], v[100:103], v[44:47]
  ds_read_b64_tr_b16 v[98:99], v18 offset:50176
  v_min_u32 v209, 0xfffffffe, v209
  s_waitcnt lgkmcnt(10)
  v_mfma_f32_16x16x32_bf16 v[40:43], v[176:179], v[104:107], v[40:43]
  ds_read_b64_tr_b16 v[100:101], v18 offset:57344
  v_min_u32 v210, 0xfffffffe, v210
  v_mfma_f32_16x16x32_bf16 v[44:47], v[180:183], v[104:107], v[44:47]
  ds_read_b64_tr_b16 v[102:103], v18 offset:58368
  v_min_u32 v211, 0xfffffffe, v211
  v_mfma_f32_16x16x32_bf16 v[40:43], v[184:187], v[108:111], v[40:43]
  ds_read_b64_tr_b16 v[104:105], v19 offset:16384
  s_nop 0
  v_mfma_f32_16x16x32_bf16 v[44:47], v[188:191], v[108:111], v[44:47]
  ds_read_b64_tr_b16 v[106:107], v19 offset:17408
  buffer_store_dwordx4 v[208:211], v30, s[36:39], 0 offen offset:0 sc1
  s_waitcnt lgkmcnt(10)
  v_mfma_f32_16x16x32_bf16 v[48:51], v[144:147], v[112:115], v[48:51]
  ds_read_b64_tr_b16 v[108:109], v19 offset:24576
  v_mfma_f32_16x16x32_bf16 v[52:55], v[148:151], v[112:115], v[52:55]
  ds_read_b64_tr_b16 v[110:111], v19 offset:25600
  v_mfma_f32_16x16x32_bf16 v[48:51], v[152:155], v[116:119], v[48:51]
  ds_read_b64_tr_b16 v[112:113], v19 offset:32768
  v_cvt_pk_bf16_f32 v212, v40, v41
  v_mfma_f32_16x16x32_bf16 v[52:55], v[156:159], v[116:119], v[52:55]
  ds_read_b64_tr_b16 v[114:115], v19 offset:33792
  v_cvt_pk_bf16_f32 v213, v42, v43
  s_waitcnt lgkmcnt(10)
  v_mfma_f32_16x16x32_bf16 v[48:51], v[160:163], v[120:123], v[48:51]
  ds_read_b64_tr_b16 v[116:117], v19 offset:40960
  v_cvt_pk_bf16_f32 v214, v44, v45
  v_mfma_f32_16x16x32_bf16 v[52:55], v[164:167], v[120:123], v[52:55]
  ds_read_b64_tr_b16 v[118:119], v19 offset:41984
  v_cvt_pk_bf16_f32 v215, v46, v47
  v_mfma_f32_16x16x32_bf16 v[48:51], v[168:171], v[124:127], v[48:51]
  ds_read_b64_tr_b16 v[120:121], v19 offset:49152
  v_min_u32 v212, 0xfffffffe, v212
  v_mfma_f32_16x16x32_bf16 v[52:55], v[172:175], v[124:127], v[52:55]
  ds_read_b64_tr_b16 v[122:123], v19 offset:50176
  v_min_u32 v213, 0xfffffffe, v213
  s_waitcnt lgkmcnt(10)
  v_mfma_f32_16x16x32_bf16 v[48:51], v[176:179], v[96:99], v[48:51]
  ds_read_b64_tr_b16 v[124:125], v19 offset:57344
  v_min_u32 v214, 0xfffffffe, v214
  v_mfma_f32_16x16x32_bf16 v[52:55], v[180:183], v[96:99], v[52:55]
  ds_read_b64_tr_b16 v[126:127], v19 offset:58368
  v_min_u32 v215, 0xfffffffe, v215
  v_mfma_f32_16x16x32_bf16 v[48:51], v[184:187], v[100:103], v[48:51]
  ds_read_b64_tr_b16 v[96:97], v20 offset:16384
  s_nop 0
  v_mfma_f32_16x16x32_bf16 v[52:55], v[188:191], v[100:103], v[52:55]
  ds_read_b64_tr_b16 v[98:99], v20 offset:17408
  buffer_store_dwordx4 v[212:215], v30, s[36:39], 0 offen offset:1024 sc1
  s_waitcnt lgkmcnt(10)
  v_mfma_f32_16x16x32_bf16 v[56:59], v[144:147], v[104:107], v[56:59]
  ds_read_b64_tr_b16 v[100:101], v20 offset:24576
  v_mfma_f32_16x16x32_bf16 v[60:63], v[148:151], v[104:107], v[60:63]
  ds_read_b64_tr_b16 v[102:103], v20 offset:25600
  v_mfma_f32_16x16x32_bf16 v[56:59], v[152:155], v[108:111], v[56:59]
  ds_read_b64_tr_b16 v[104:105], v20 offset:32768
  v_cvt_pk_bf16_f32 v216, v48, v49
  v_mfma_f32_16x16x32_bf16 v[60:63], v[156:159], v[108:111], v[60:63]
  ds_read_b64_tr_b16 v[106:107], v20 offset:33792
  v_cvt_pk_bf16_f32 v217, v50, v51
  s_waitcnt lgkmcnt(10)
  v_mfma_f32_16x16x32_bf16 v[56:59], v[160:163], v[112:115], v[56:59]
  ds_read_b64_tr_b16 v[108:109], v20 offset:40960
  v_cvt_pk_bf16_f32 v218, v52, v53
  v_mfma_f32_16x16x32_bf16 v[60:63], v[164:167], v[112:115], v[60:63]
  ds_read_b64_tr_b16 v[110:111], v20 offset:41984
  v_cvt_pk_bf16_f32 v219, v54, v55
  v_mfma_f32_16x16x32_bf16 v[56:59], v[168:171], v[116:119], v[56:59]
  ds_read_b64_tr_b16 v[112:113], v20 offset:49152
  v_min_u32 v216, 0xfffffffe, v216
  v_mfma_f32_16x16x32_bf16 v[60:63], v[172:175], v[116:119], v[60:63]
  ds_read_b64_tr_b16 v[114:115], v20 offset:50176
  v_min_u32 v217, 0xfffffffe, v217
  s_waitcnt lgkmcnt(10)
  v_mfma_f32_16x16x32_bf16 v[56:59], v[176:179], v[120:123], v[56:59]
  ds_read_b64_tr_b16 v[116:117], v20 offset:57344
  v_min_u32 v218, 0xfffffffe, v218
  v_mfma_f32_16x16x32_bf16 v[60:63], v[180:183], v[120:123], v[60:63]
  ds_read_b64_tr_b16 v[118:119], v20 offset:58368
  v_min_u32 v219, 0xfffffffe, v219
  v_mfma_f32_16x16x32_bf16 v[56:59], v[184:187], v[124:127], v[56:59]
  ds_read_b64_tr_b16 v[120:121], v21 offset:16384
  s_nop 0
  v_mfma_f32_16x16x32_bf16 v[60:63], v[188:191], v[124:127], v[60:63]
  ds_read_b64_tr_b16 v[122:123], v21 offset:17408
  buffer_store_dwordx4 v[216:219], v30, s[36:39], 0 offen offset:2048 sc1
  s_waitcnt lgkmcnt(10)
  v_mfma_f32_16x16x32_bf16 v[64:67], v[144:147], v[96:99], v[64:67]
  ds_read_b64_tr_b16 v[124:125], v21 offset:24576
  v_mfma_f32_16x16x32_bf16 v[68:71], v[148:151], v[96:99], v[68:71]
  ds_read_b64_tr_b16 v[126:127], v21 offset:25600
  v_mfma_f32_16x16x32_bf16 v[64:67], v[152:155], v[100:103], v[64:67]
  ds_read_b64_tr_b16 v[96:97], v21 offset:32768
  v_cvt_pk_bf16_f32 v220, v56, v57
  v_mfma_f32_16x16x32_bf16 v[68:71], v[156:159], v[100:103], v[68:71]
  ds_read_b64_tr_b16 v[98:99], v21 offset:33792
  v_cvt_pk_bf16_f32 v221, v58, v59
  s_waitcnt lgkmcnt(10)
  v_mfma_f32_16x16x32_bf16 v[64:67], v[160:163], v[104:107], v[64:67]
  ds_read_b64_tr_b16 v[100:101], v21 offset:40960
  v_cvt_pk_bf16_f32 v222, v60, v61
  v_mfma_f32_16x16x32_bf16 v[68:71], v[164:167], v[104:107], v[68:71]
  ds_read_b64_tr_b16 v[102:103], v21 offset:41984
  v_cvt_pk_bf16_f32 v223, v62, v63
  v_mfma_f32_16x16x32_bf16 v[64:67], v[168:171], v[108:111], v[64:67]
  ds_read_b64_tr_b16 v[104:105], v21 offset:49152
  v_min_u32 v220, 0xfffffffe, v220
  v_mfma_f32_16x16x32_bf16 v[68:71], v[172:175], v[108:111], v[68:71]
  ds_read_b64_tr_b16 v[106:107], v21 offset:50176
  v_min_u32 v221, 0xfffffffe, v221
  s_waitcnt lgkmcnt(10)
  v_mfma_f32_16x16x32_bf16 v[64:67], v[176:179], v[112:115], v[64:67]
  ds_read_b64_tr_b16 v[108:109], v21 offset:57344
  v_min_u32 v222, 0xfffffffe, v222
  v_mfma_f32_16x16x32_bf16 v[68:71], v[180:183], v[112:115], v[68:71]
  ds_read_b64_tr_b16 v[110:111], v21 offset:58368
  v_min_u32 v223, 0xfffffffe, v223
  v_mfma_f32_16x16x32_bf16 v[64:67], v[184:187], v[116:119], v[64:67]
  ds_read_b64_tr_b16 v[112:113], v22 offset:16384
  s_nop 0
  v_mfma_f32_16x16x32_bf16 v[68:71], v[188:191], v[116:119], v[68:71]
  ds_read_b64_tr_b16 v[114:115], v22 offset:17408
  buffer_store_dwordx4 v[220:223], v30, s[36:39], 0 offen offset:3072 sc1
  s_waitcnt lgkmcnt(10)
  v_mfma_f32_16x16x32_bf16 v[72:75], v[144:147], v[120:123], v[72:75]
  ds_read_b64_tr_b16 v[116:117], v22 offset:24576
  v_mfma_f32_16x16x32_bf16 v[76:79], v[148:151], v[120:123], v[76:79]
  ds_read_b64_tr_b16 v[118:119], v22 offset:25600
  v_mfma_f32_16x16x32_bf16 v[72:75], v[152:155], v[124:127], v[72:75]
  ds_read_b64_tr_b16 v[120:121], v22 offset:32768
  v_mfma_f32_16x16x32_bf16 v[76:79], v[156:159], v[124:127], v[76:79]
  ds_read_b64_tr_b16 v[122:123], v22 offset:33792
  s_waitcnt lgkmcnt(10)
  v_mfma_f32_16x16x32_bf16 v[72:75], v[160:163], v[96:99], v[72:75]
  ds_read_b64_tr_b16 v[124:125], v22 offset:40960
  v_mfma_f32_16x16x32_bf16 v[76:79], v[164:167], v[96:99], v[76:79]
  ds_read_b64_tr_b16 v[126:127], v22 offset:41984
  v_mfma_f32_16x16x32_bf16 v[72:75], v[168:171], v[100:103], v[72:75]
  ds_read_b64_tr_b16 v[96:97], v22 offset:49152
  v_mfma_f32_16x16x32_bf16 v[76:79], v[172:175], v[100:103], v[76:79]
  ds_read_b64_tr_b16 v[98:99], v22 offset:50176
  s_waitcnt lgkmcnt(10)
  v_mfma_f32_16x16x32_bf16 v[72:75], v[176:179], v[104:107], v[72:75]
  ds_read_b64_tr_b16 v[100:101], v22 offset:57344
  v_mfma_f32_16x16x32_bf16 v[76:79], v[180:183], v[104:107], v[76:79]
  ds_read_b64_tr_b16 v[102:103], v22 offset:58368
  v_mfma_f32_16x16x32_bf16 v[72:75], v[184:187], v[108:111], v[72:75]
  ds_read_b64_tr_b16 v[104:105], v23 offset:16384
  v_mfma_f32_16x16x32_bf16 v[76:79], v[188:191], v[108:111], v[76:79]
  ds_read_b64_tr_b16 v[106:107], v23 offset:17408
  s_waitcnt lgkmcnt(10)
  v_mfma_f32_16x16x32_bf16 v[80:83], v[144:147], v[112:115], v[80:83]
  ds_read_b64_tr_b16 v[108:109], v23 offset:24576
  v_mfma_f32_16x16x32_bf16 v[84:87], v[148:151], v[112:115], v[84:87]
  ds_read_b64_tr_b16 v[110:111], v23 offset:25600
  v_mfma_f32_16x16x32_bf16 v[80:83], v[152:155], v[116:119], v[80:83]
  ds_read_b64_tr_b16 v[112:113], v23 offset:32768
  v_mfma_f32_16x16x32_bf16 v[84:87], v[156:159], v[116:119], v[84:87]
  ds_read_b64_tr_b16 v[114:115], v23 offset:33792
  s_waitcnt lgkmcnt(10)
  v_mfma_f32_16x16x32_bf16 v[80:83], v[160:163], v[120:123], v[80:83]
  ds_read_b64_tr_b16 v[116:117], v23 offset:40960
  v_mfma_f32_16x16x32_bf16 v[84:87], v[164:167], v[120:123], v[84:87]
  ds_read_b64_tr_b16 v[118:119], v23 offset:41984
  v_mfma_f32_16x16x32_bf16 v[80:83], v[168:171], v[124:127], v[80:83]
  ds_read_b64_tr_b16 v[120:121], v23 offset:49152
  v_mfma_f32_16x16x32_bf16 v[84:87], v[172:175], v[124:127], v[84:87]
  ds_read_b64_tr_b16 v[122:123], v23 offset:50176
  s_waitcnt lgkmcnt(10)
  v_mfma_f32_16x16x32_bf16 v[80:83], v[176:179], v[96:99], v[80:83]
  ds_read_b64_tr_b16 v[124:125], v23 offset:57344
  v_mfma_f32_16x16x32_bf16 v[84:87], v[180:183], v[96:99], v[84:87]
  ds_read_b64_tr_b16 v[126:127], v23 offset:58368
  v_mfma_f32_16x16x32_bf16 v[80:83], v[184:187], v[100:103], v[80:83]
  v_mfma_f32_16x16x32_bf16 v[84:87], v[188:191], v[100:103], v[84:87]
  s_waitcnt lgkmcnt(8)
  v_mfma_f32_16x16x32_bf16 v[88:91], v[144:147], v[104:107], v[88:91]
  v_mfma_f32_16x16x32_bf16 v[92:95], v[148:151], v[104:107], v[92:95]
  v_mfma_f32_16x16x32_bf16 v[88:91], v[152:155], v[108:111], v[88:91]
  v_mfma_f32_16x16x32_bf16 v[92:95], v[156:159], v[108:111], v[92:95]
  s_waitcnt lgkmcnt(4)
  v_mfma_f32_16x16x32_bf16 v[88:91], v[160:163], v[112:115], v[88:91]
  v_mfma_f32_16x16x32_bf16 v[92:95], v[164:167], v[112:115], v[92:95]
  v_mfma_f32_16x16x32_bf16 v[88:91], v[168:171], v[116:119], v[88:91]
  v_mfma_f32_16x16x32_bf16 v[92:95], v[172:175], v[116:119], v[92:95]
  s_waitcnt lgkmcnt(0)
  v_mfma_f32_16x16x32_bf16 v[88:91], v[176:179], v[120:123], v[88:91]
  v_mfma_f32_16x16x32_bf16 v[92:95], v[180:183], v[120:123], v[92:95]
  v_mfma_f32_16x16x32_bf16 v[88:91], v[184:187], v[124:127], v[88:91]
  v_mfma_f32_16x16x32_bf16 v[92:95], v[188:191], v[124:127], v[92:95]
  s_mov_b32 s11, 200000
g2x_poll:
  buffer_load_dwordx4 v[128:131], v29, s[36:39], 0 offen offset:0 sc1
  buffer_load_dwordx4 v[132:135], v29, s[36:39], 0 offen offset:1024 sc1
  buffer_load_dwordx4 v[136:139], v29, s[36:39], 0 offen offset:2048 sc1
  buffer_load_dwordx4 v[140:143], v29, s[36:39], 0 offen offset:3072 sc1
  s_waitcnt vmcnt(0)
  v_max3_u32 v12, v128, v129, v130
  v_max3_u32 v13, v131, v132, v133
  v_max3_u32 v12, v12, v134, v135
  v_max3_u32 v13, v13, v136, v137
  v_max3_u32 v13, v13, v138, v139
  v_max3_u32 v13, v13, v140, v141
  v_max3_u32 v13, v13, v142, v143
  v_max_u32 v12, v12, v13
  v_cmp_eq_u32 vcc, -1, v12
  s_sub_u32 s11, s11, 1
  s_cmp_eq_u32 s11, 0
  s_cbranch_scc1 g2x_got
  s_cmp_lg_u64 vcc, 0
  s_cbranch_scc1 g2x_poll
g2x_got:
  s_mov_b32 s46, 0xffff0000
  v_mul_u32_u24 v14, 272, v8
  v_lshl_add_u32 v14, v9, 4, v14
  s_lshl_b32 s47, s20, 6
  s_add_u32 s47, s47, 65536
  v_add_u32 v14, s47, v14
  v_lshlrev_b32 v24, 16, v24
  v_lshlrev_b32 v25, 16, v25
  v_lshlrev_b32 v26, 16, v26
  v_lshlrev_b32 v27, 16, v27
  v_lshlrev_b32 v96, 16, v128
  v_and_b32 v97, s46, v128
  v_lshlrev_b32 v98, 16, v192
  v_and_b32 v99, s46, v192
  v_pk_add_f32 v[96:97], v[96:97], v[64:65]
  v_pk_add_f32 v[96:97], v[96:97], v[98:99]
  v_add_f32 v96, v96, v24
  v_add_f32 v97, v97, v24
  v_cvt_pk_bf16_f32 v112, v96, v97
  v_lshlrev_b32 v100, 16, v129
  v_and_b32 v101, s46, v129
  v_lshlrev_b32 v102, 16, v193
  v_and_b32 v103, s46, v193
  v_pk_add_f32 v[100:101], v[100:101], v[66:67]
  v_pk_add_f32 v[100:101], v[100:101], v[102:103]
  v_add_f32 v100, v100, v24
  v_add_f32 v101, v101, v24
  v_cvt_pk_bf16_f32 v113, v100, v101
  v_lshlrev_b32 v96, 16, v130
  v_and_b32 v97, s46, v130
  v_lshlrev_b32 v98, 16, v194
  v_and_b32 v99, s46, v194
  v_pk_add_f32 v[96:97], v[96:97], v[68:69]
  v_pk_add_f32 v[96:97], v[96:97], v[98:99]
  v_add_f32 v96, v96, v24
  v_add_f32 v97, v97, v24
  v_cvt_pk_bf16_f32 v114, v96, v97
  v_lshlrev_b32 v100, 16, v131
  v_and_b32 v101, s46, v131
  v_lshlrev_b32 v102, 16, v195
  v_and_b32 v103, s46, v195
  v_pk_add_f32 v[100:101], v[100:101], v[70:71]
  v_pk_add_f32 v[100:101], v[100:101], v[102:103]
  v_add_f32 v100, v100, v24
  v_add_f32 v101, v101, v24
  v_cvt_pk_bf16_f32 v115, v100, v101
  ds_write_b128 v14, v[112:115] offset:0
  v_lshlrev_b32 v96, 16, v132
  v_and_b32 v97, s46, v132
  v_lshlrev_b32 v98, 16, v196
  v_and_b32 v99, s46, v196
  v_pk_add_f32 v[96:97], v[96:97], v[72:73]
  v_pk_add_f32 v[96:97], v[96:97], v[98:99]
  v_add_f32 v96, v96, v25
  v_add_f32 v97, v97, v25
  v_cvt_pk_bf16_f32 v116, v96, v97
  v_lshlrev_b32 v100, 16, v133
  v_and_b32 v101, s46, v133
  v_lshlrev_b32 v102, 16, v197
  v_and_b32 v103, s46, v197
  v_pk_add_f32 v[100:101], v[100:101], v[74:75]
  v_pk_add_f32 v[100:101], v[100:101], v[102:103]
  v_add_f32 v100, v100, v25
  v_add_f32 v101, v101, v25
  v_cvt_pk_bf16_f32 v117, v100, v101
  v_lshlrev_b32 v96, 16, v134
  v_and_b32 v97, s46, v134
  v_lshlrev_b32 v98, 16, v198
  v_and_b32 v99, s46, v198
  v_pk_add_f32 v[96:97], v[96:97], v[76:77]
  v_pk_add_f32 v[96:97], v[96:97], v[98:99]
  v_add_f32 v96, v96, v25
  v_add_f32 v97, v97, v25
  v_cvt_pk_bf16_f32 v118, v96, v97
  v_lshlrev_b32 v100, 16, v135
  v_and_b32 v101, s46, v135
  v_lshlrev_b32 v102, 16, v199
  v_and_b32 v103, s46, v199
  v_pk_add_f32 v[100:101], v[100:101], v[78:79]
  v_pk_add_f32 v[100:101], v[100:101], v[102:103]
  v_add_f32 v100, v100, v25
  v_add_f32 v101, v101, v25
  v_cvt_pk_bf16_f32 v119, v100, v101
  ds_write_b128 v14, v[116:119] offset:4352
  v_lshlrev_b32 v96, 16, v136
  v_and_b32 v97, s46, v136
  v_lshlrev_b32 v98, 16, v200
  v_and_b32 v99, s46, v200
  v_pk_add_f32 v[96:97], v[96:97], v[80:81]
  v_pk_add_f32 v[96:97], v[96:97], v[98:99]
  v_add_f32 v96, v96, v26
  v_add_f32 v97, v97, v26
  v_cvt_pk_bf16_f32 v120, v96, v97
  v_lshlrev_b32 v100, 16, v137
  v_and_b32 v101, s46, v137
  v_lshlrev_b32 v102, 16, v201
  v_and_b32 v103, s46, v201
  v_pk_add_f32 v[100:101], v[100:101], v[82:83]
  v_pk_add_f32 v[100:101], v[100:101], v[102:103]
  v_add_f32 v100, v100, v26
  v_add_f32 v101, v101, v26
  v_cvt_pk_bf16_f32 v121, v100, v101
  v_lshlrev_b32 v96, 16, v138
  v_and_b32 v97, s46, v138
  v_lshlrev_b32 v98, 16, v202
  v_and_b32 v99, s46, v202
  v_pk_add_f32 v[96:97], v[96:97], v[84:85]
  v_pk_add_f32 v[96:97], v[96:97], v[98:99]
  v_add_f32 v96, v96, v26
  v_add_f32 v97, v97, v26
  v_cvt_pk_bf16_f32 v122, v96, v97
  v_lshlrev_b32 v100, 16, v139
  v_and_b32 v101, s46, v139
  v_lshlrev_b32 v102, 16, v203
  v_and_b32 v103, s46, v203
  v_pk_add_f32 v[100:101], v[100:101], v[86:87]
  v_pk_add_f32 v[100:101], v[100:101], v[102:103]
  v_add_f32 v100, v100, v26
  v_add_f32 v101, v101, v26
  v_cvt_pk_bf16_f32 v123, v100, v101
  ds_write_b128 v14, v[120:123] offset:8704
  v_lshlrev_b32 v96, 16, v140
  v_and_b32 v97, s46, v140
  v_lshlrev_b32 v98, 16, v204
  v_and_b32 v99, s46, v204
  v_pk_add_f32 v[96:97], v[96:97], v[88:89]
  v_pk_add_f32 v[96:97], v[96:97], v[98:99]
  v_add_f32 v96, v96, v27
  v_add_f32 v97, v97, v27
  v_cvt_pk_bf16_f32 v124, v96, v97
  v_lshlrev_b32 v100, 16, v141
  v_and_b32 v101, s46, v141
  v_lshlrev_b32 v102, 16, v205
  v_and_b32 v103, s46, v205
  v_pk_add_f32 v[100:101], v[100:101], v[90:91]
  v_pk_add_f32 v[100:101], v[100:101], v[102:103]
  v_add_f32 v100, v100, v27
  v_add_f32 v101, v101, v27
  v_cvt_pk_bf16_f32 v125, v100, v101
  v_lshlrev_b32 v96, 16, v142
  v_and_b32 v97, s46, v142
  v_lshlrev_b32 v98, 16, v206
  v_and_b32 v99, s46, v206
  v_pk_add_f32 v[96:97], v[96:97], v[92:93]
  v_pk_add_f32 v[96:97], v[96:97], v[98:99]
  v_add_f32 v96, v96, v27
  v_add_f32 v97, v97, v27
  v_cvt_pk_bf16_f32 v126, v96, v97
  v_lshlrev_b32 v100, 16, v143
  v_and_b32 v101, s46, v143
  v_lshlrev_b32 v102, 16, v207
  v_and_b32 v103, s46, v207
  v_pk_add_f32 v[100:101], v[100:101], v[94:95]
  v_pk_add_f32 v[100:101], v[100:101], v[102:103]
  v_add_f32 v100, v100, v27
  v_add_f32 v101, v101, v27
  v_cvt_pk_bf16_f32 v127, v100, v101
  ds_write_b128 v14, v[124:127] offset:13056
  v_lshrrev_b32 v15, 4, v7
  s_lshl_b32 s47, s20, 4
  v_add_u32 v15, s47, v15
  v_and_b32 v12, 15, v7
  v_mul_u32_u24 v14, 272, v15
  v_lshl_add_u32 v14, v12, 4, v14
  v_add_u32 v14, 65536, v14
  s_lshl_b32 s47, s45, 7
  s_lshl_b32 s48, s19, 6
  s_add_u32 s47, s47, s48
  v_add_u32 v15, s47, v15
  v_lshlrev_b32 v15, 11, v15
  v_lshl_add_u32 v15, v12, 4, v15
  s_lshl_b32 s47, s44, 8
  v_add_u32 v15, s47, v15
  s_waitcnt lgkmcnt(0)
  s_barrier
  ds_read_b128 v[96:99], v14 offset:0
  ds_read_b128 v[100:103], v14 offset:1088
  ds_read_b128 v[104:107], v14 offset:2176
  ds_read_b128 v[108:111], v14 offset:3264
  s_waitcnt lgkmcnt(3)
  s_mov_b32 s47, 0
  buffer_store_dwordx4 v[96:99], v15, s[32:35], s47 offen sc1
  s_waitcnt lgkmcnt(2)
  s_mov_b32 s47, 8192
  buffer_store_dwordx4 v[100:103], v15, s[32:35], s47 offen sc1
  s_waitcnt lgkmcnt(1)
  s_mov_b32 s47, 16384
  buffer_store_dwordx4 v[104:107], v15, s[32:35], s47 offen sc1
  s_waitcnt lgkmcnt(0)
  s_mov_b32 s47, 24576
  buffer_store_dwordx4 v[108:111], v15, s[32:35], s47 offen sc1
  s_branch g2_done
g2_loader:
  s_barrier
  s_waitcnt vmcnt(4)
  s_barrier
  s_add_u32 m0, s5, 0
  s_nop 0
  buffer_load_dwordx4 v224, s[28:31], s4 offen lds
  s_add_u32 m0, s5, 4096
  s_nop 0
  buffer_load_dwordx4 v225, s[28:31], s4 offen lds
  s_add_u32 m0, s5, 8192
  s_nop 0
  buffer_load_dwordx4 v226, s[28:31], s4 offen lds
  s_add_u32 m0, s5, 12288
  s_nop 0
  buffer_load_dwordx4 v227, s[28:31], s4 offen lds
  s_add_u32 s4, s4, s9
  s_add_u32 s5, s5, 16384
  s_cmp_ge_u32 s5, s7
  s_cselect_b32 s8, 131072, 0
  s_sub_u32 s5, s5, s8
  s_add_u32 m0, s5, 0
  s_nop 0
  buffer_load_dwordx4 v224, s[28:31], s4 offen lds
  s_add_u32 m0, s5, 4096
  s_nop 0
  buffer_load_dwordx4 v225, s[28:31], s4 offen lds
  s_add_u32 m0, s5, 8192
  s_nop 0
  buffer_load_dwordx4 v226, s[28:31], s4 offen lds
  s_add_u32 m0, s5, 12288
  s_nop 0
  buffer_load_dwordx4 v227, s[28:31], s4 offen lds
  s_add_u32 s4, s4, s9
  s_add_u32 s5, s5, 16384
  s_cmp_ge_u32 s5, s7
  s_cselect_b32 s8, 131072, 0
  s_sub_u32 s5, s5, s8
  s_add_u32 m0, s5, 0
  s_nop 0
  buffer_load_dwordx4 v224, s[28:31], s4 offen lds
  s_add_u32 m0, s5, 4096
  s_nop 0
  buffer_load_dwordx4 v225, s[28:31], s4 offen lds
  s_add_u32 m0, s5, 8192
  s_nop 0
  buffer_load_dwordx4 v226, s[28:31], s4 offen lds
  s_add_u32 m0, s5, 12288
  s_nop 0
  buffer_load_dwordx4 v227, s[28:31], s4 offen lds
  s_add_u32 s4, s4, s9
  s_add_u32 s5, s5, 16384
  s_cmp_ge_u32 s5, s7
  s_cselect_b32 s8, 131072, 0
  s_sub_u32 s5, s5, s8
  s_add_u32 m0, s5, 0
  s_nop 0
  buffer_load_dwordx4 v224, s[28:31], s4 offen lds
  s_add_u32 m0, s5, 4096
  s_nop 0
  buffer_load_dwordx4 v225, s[28:31], s4 offen lds
  s_add_u32 m0, s5, 8192
  s_nop 0
  buffer_load_dwordx4 v226, s[28:31], s4 offen lds
  s_add_u32 m0, s5, 12288
  s_nop 0
  buffer_load_dwordx4 v227, s[28:31], s4 offen lds
  s_add_u32 s4, s4, s9
  s_add_u32 s5, s5, 16384
  s_cmp_ge_u32 s5, s7
  s_cselect_b32 s8, 131072, 0
  s_sub_u32 s5, s5, s8
  s_add_u32 m0, s5, 0
  s_nop 0
  buffer_load_dwordx4 v224, s[28:31], s4 offen lds
  s_add_u32 m0, s5, 4096
  s_nop 0
  buffer_load_dwordx4 v225, s[28:31], s4 offen lds
  s_add_u32 m0, s5, 8192
  s_nop 0
  buffer_load_dwordx4 v226, s[28:31], s4 offen lds
  s_add_u32 m0, s5, 12288
  s_nop 0
  buffer_load_dwordx4 v227, s[28:31], s4 offen lds
  s_add_u32 s4, s4, s9
  s_add_u32 s5, s5, 16384
  s_cmp_ge_u32 s5, s7
  s_cselect_b32 s8, 131072, 0
  s_sub_u32 s5, s5, s8
  s_mov_b32 s6, 21
g2_lloop:
  s_waitcnt vmcnt(20)
  s_barrier
  s_add_u32 m0, s5, 0
  s_nop 0
  buffer_load_dwordx4 v224, s[28:31], s4 offen lds
  s_add_u32 m0, s5, 4096
  s_nop 0
  buffer_load_dwordx4 v225, s[28:31], s4 offen lds
  s_add_u32 m0, s5, 8192
  s_nop 0
  buffer_load_dwordx4 v226, s[28:31], s4 offen lds
  s_add_u32 m0, s5, 12288
  s_nop 0
  buffer_load_dwordx4 v227, s[28:31], s4 offen lds
  s_add_u32 s4, s4, s9
  s_add_u32 s5, s5, 16384
  s_cmp_ge_u32 s5, s7
  s_cselect_b32 s8, 131072, 0
  s_sub_u32 s5, s5, s8
  s_sub_u32 s6, s6, 1
  s_cmp_lg_u32 s6, 0
  s_cbranch_scc1 g2_lloop
  s_waitcnt vmcnt(20)
  s_barrier
  s_waitcnt vmcnt(16)
  s_barrier
  s_waitcnt vmcnt(12)
  s_barrier
  s_waitcnt vmcnt(8)
  s_barrier
  s_waitcnt vmcnt(4)
  s_barrier
  s_waitcnt vmcnt(0)
  s_barrier
g2_done:
  s_waitcnt vmcnt(0)
k_exit:
  s_endpgm
.section .rodata,"a"
.p2align 6
.amdhsa_kernel sequential_preLN__spectral_gfnet__mixer_token_mlp__prompt_kernel
  .amdhsa_next_free_vgpr 240
  .amdhsa_next_free_sgpr 102
  .amdhsa_accum_offset 240
  .amdhsa_group_segment_fixed_size 0
  .amdhsa_kernarg_size 88
  .amdhsa_user_sgpr_count 2
  .amdhsa_user_sgpr_kernarg_segment_ptr 1
  .amdhsa_system_sgpr_workgroup_id_x 1
  .amdhsa_float_denorm_mode_32 3
.end_amdhsa_kernel
.text
```
